```python
import torch

def _softmax(x, axis=-1):
    return torch.softmax(x, dim=axis)
def _gelu(x):
    return torch.nn.functional.gelu(x, approximate="tanh")
def _silu(x):
    return torch.nn.functional.silu(x)
def _sigmoid(x):
    return torch.sigmoid(x)
def _layernorm(x, axis=-1, eps=1e-5):
    m = x.mean(dim=axis, keepdim=True)
    v = x.var(dim=axis, keepdim=True, unbiased=False)
    return (x - m) / torch.sqrt(v + eps)
def _scatter_add(tgt, idx, src, axis=0):
    return tgt.clone().index_add_(axis, idx, src)
def _segment_sum(src, seg, n):
    out = torch.zeros((n,) + src.shape[1:], dtype=src.dtype)
    return out.index_add_(0, seg, src)
def _pad(x, pw):
    flat = tuple(v for pair in reversed(pw) for v in pair)
    return torch.nn.functional.pad(x, flat)

kernel_name = 'recurrent_scan__ssm_conv_s4__mixer_token_mlp__prompt'

def setup_inputs():

    _w = (lambda a: (lambda t: t.to(torch.bfloat16) if t.is_floating_point() else t)(torch.as_tensor(a)))
    def _A_setup():
        B, L, D, N = 1, 2048, 512, 128
        A_re = -(lambda _x: torch.exp(torch.as_tensor(_x)))((lambda *s: torch.randn(*s, dtype=torch.bfloat16) * 3.2)(D, N))
        A_im = torch.pi * (lambda *s: torch.randn(*s, dtype=torch.bfloat16) * 0.2)(D, N)
        B_re = (lambda *s: torch.randn(*s, dtype=torch.bfloat16) * 0.2)(D, N)
        B_im = (lambda *s: torch.randn(*s, dtype=torch.bfloat16) * 0.2)(D, N)
        C_re = (lambda *s: torch.randn(*s, dtype=torch.bfloat16) * 0.2)(D, N)
        C_im = (lambda *s: torch.randn(*s, dtype=torch.bfloat16) * 0.2)(D, N)
        log_dt = (lambda *s: torch.randn(*s, dtype=torch.bfloat16) * 0.2)(D) * 0.5 - 4.0
        Dskip = (lambda *s: torch.randn(*s, dtype=torch.bfloat16) * 0.2)(D)
        return {
            "u": _w((lambda *s: torch.randn(*s, dtype=torch.bfloat16) * 0.05)(B, L, D)),
            "A_re": _w(A_re),
            "A_im": _w(A_im),
            "B_re": _w(B_re),
            "B_im": _w(B_im),
            "C_re": _w(C_re),
            "C_im": _w(C_im),
            "log_dt": _w(log_dt),
            "Dskip": _w(Dskip),
        }
    _A_in = _A_setup()

    def _B_setup():
        B, S, D, F = 1, 2048, 512, 1792
        return {
            "x": _w((lambda *s: torch.randn(*s, dtype=torch.bfloat16) * 0.05)(B, S, D)),
            "w1": _w((lambda *s: torch.randn(*s, dtype=torch.bfloat16) * 0.8)(S, F) * (S ** -0.5)),
            "b1": _w((lambda *s: torch.randn(*s, dtype=torch.bfloat16) * 12.8)(F) * 0.02),
            "w2": _w((lambda *s: torch.randn(*s, dtype=torch.bfloat16) * 0.2)(F, S) * (F ** -0.5)),
            "b2": _w((lambda *s: torch.randn(*s, dtype=torch.bfloat16) * 1.6)(S) * 0.02),
        }
    _B_in = _B_setup()

    return {
        "A_u": _A_in["u"],
        "A_A_re": _A_in["A_re"],
        "A_A_im": _A_in["A_im"],
        "A_B_re": _A_in["B_re"],
        "A_B_im": _A_in["B_im"],
        "A_C_re": _A_in["C_re"],
        "A_C_im": _A_in["C_im"],
        "A_log_dt": _A_in["log_dt"],
        "A_Dskip": _A_in["Dskip"],
        "B_x": _B_in["x"],
        "B_w1": _B_in["w1"],
        "B_b1": _B_in["b1"],
        "B_w2": _B_in["w2"],
        "B_b2": _B_in["b2"],
    }

def reference(A_u, A_A_re, A_A_im, A_B_re, A_B_im, A_C_re, A_C_im, A_log_dt, A_Dskip, B_x, B_w1, B_b1, B_w2, B_b2):
    def _A_ref(u, A_re, A_im, B_re, B_im, C_re, C_im, log_dt, Dskip):
        Bsz, L, D = u.shape
        dt = torch.exp(log_dt)[:, None]
        A = A_re + 1j * A_im
        Bc = B_re + 1j * B_im
        Cc = C_re + 1j * C_im
        logdA = dt * A
        dB = dt * Bc
        l = (lambda x, dt: x.to(dt))(torch.arange(L), A_re.dtype)
        P = torch.exp(logdA[:, :, None] * l[None, None, :])
        K = torch.einsum("dn,dnl,dn->dl", Cc, P, dB).real
        L2 = 2 * L
        Kp = _pad(K, ((0, 0), (0, L)))
        up = (lambda x, *d: x.permute(*d))(u, 0, 2, 1)
        up = _pad(up, ((0, 0), (0, 0), (0, L)))
        Kf = (lambda x, axes=(-2,-1): torch.fft.rfft2(x.float(), dim=axes))(Kp[:, None, :], axes=(-2, -1))
        Uf = (lambda x, axes=(-2,-1): torch.fft.rfft2(x.float(), dim=axes))(up[:, :, None, :], axes=(-2, -1))
        Yf = Uf * Kf[None, :, :, :]
        y = (lambda x, s, axes=(-2,-1): torch.fft.irfft2(x, s=s, dim=axes).to(torch.bfloat16))(Yf, (1, L2), axes=(-2, -1))[:, :, 0, :L]
        y = (lambda x, *d: x.permute(*d))(y, 0, 2, 1) + u * Dskip[None, None, :]
        return y

    def _B_ref(x, w1, b1, w2, b2):
        B, S, D = x.shape
        h = _layernorm(x, axis=-1)
        u = torch.einsum("bsd,sf->bdf", h, w1) + b1
        u = _gelu(u)
        y = torch.einsum("bdf,fs->bds", u, w2) + b2
        return (lambda x, *d: x.permute(*d))(y, 0, 2, 1)

    x = A_u
    xn = _layernorm(x, axis=-1)
    s = _A_ref(xn, A_A_re, A_A_im, A_B_re, A_B_im, A_C_re, A_C_im, A_log_dt, A_Dskip)
    g = _silu(_B_ref(xn, B_w1, B_b1, B_w2, B_b2))
    return x + s * g
```

```asm
; @launch grid=(256,1,1) block=(256,1,1) lds=163840
.amdgcn_target "amdgcn-amd-amdhsa--gfx950"
.text
.globl recurrent_scan__ssm_conv_s4__mixer_token_mlp__prompt_kernel
.p2align 8
.type recurrent_scan__ssm_conv_s4__mixer_token_mlp__prompt_kernel,@function
recurrent_scan__ssm_conv_s4__mixer_token_mlp__prompt_kernel:
    s_cmp_ge_u32 s2, 256
    s_cbranch_scc1 L_done
    s_load_dwordx16 s[48:63], s[0:1], 0
    s_load_dwordx16 s[64:79], s[0:1], 64
    s_load_dwordx2 s[80:81], s[0:1], 128
    v_lshrrev_b32 v4, 6, v0
    v_and_b32 v1, 63, v0
    v_readfirstlane_b32 s12, v4
    s_and_b32 s24, s2, 7
    s_lshr_b32 s25, s2, 3
    s_lshl_b32 s14, s24, 5
    s_add_u32 s14, s14, s25
    s_lshl_b32 s26, s14, 13
    s_lshl_b32 s27, s12, 11
    s_add_u32 s26, s26, s27
    v_lshl_add_u32 v2, v1, 4, s26
    s_waitcnt lgkmcnt(0)
    global_load_dwordx4 v[8:11], v2, s[48:49] nt
    global_load_dwordx4 v[12:15], v2, s[48:49] offset:1024 nt
    s_add_u32 s26, s2, s12
    s_cmp_lg_u32 s26, 0
    s_cbranch_scc1 L_notag
    s_memrealtime s[26:27]
    v_mov_b32 v4, 0
    s_waitcnt lgkmcnt(0)
    s_and_b32 s26, s26, -4
    s_or_b32 s27, s27, 0x40000000
    v_mov_b32 v6, s26
    v_mov_b32 v7, s27
    s_mov_b64 exec, 1
    global_store_dwordx2 v4, v[6:7], s[78:79] sc1
    s_mov_b64 exec, -1
L_notag:
    s_min_u32 s26, s25, 27
    s_mul_i32 s27, s26, 37
    s_lshr_b32 s27, s27, 8
    s_mul_i32 s28, s27, 7
    s_sub_u32 s26, s26, s28
    s_lshr_b32 s28, s24, 1
    s_mul_i32 s15, s28, 7
    s_add_u32 s15, s15, s26
    s_and_b32 s29, s24, 1
    s_lshl_b32 s29, s29, 2
    s_add_u32 s16, s29, s27
    s_lshl_b32 s94, s27, 1
    s_add_u32 s94, s94, s26
    s_and_b32 s94, s94, 7
    s_lshl_b32 s17, s28, 3
    s_and_b32 s26, s25, 7
    s_lshr_b32 s27, s25, 3
    s_add_u32 s95, s27, 4
    s_cmp_eq_u32 s26, 3
    s_cselect_b32 s26, s95, s26
    s_cselect_b32 s27, 3, s27
    s_sub_u32 s95, s25, 28
    s_cmp_ge_u32 s25, 28
    s_cselect_b32 s26, 3, s26
    s_cselect_b32 s27, s95, s27
    s_add_u32 s17, s17, s26
    s_add_u32 s18, s29, s27
    s_lshl_b32 s95, s27, 1
    s_add_u32 s95, s95, s26
    s_cmp_ge_u32 s95, 7
    s_cselect_b32 s26, 7, 0
    s_sub_u32 s95, s95, s26
    s_mul_i32 s13, s12, 40960
    s_lshr_b32 s19, s12, 1
    s_and_b32 s20, s12, 1
    s_lshl_b32 s21, s14, 1
    s_add_u32 s21, s21, s19
    v_lshrrev_b32 v26, 3, v1
    v_mul_u32_u24 v26, 3584, v26
    v_and_b32 v27, 7, v1
    v_lshl_add_u32 v26, v27, 4, v26
    v_and_b32 v27, 16, v1
    v_lshlrev_b32 v27, 2, v27
    v_xor_b32 v26, v26, v27
    s_lshl_b32 s26, s15, 7
    v_add_u32 v16, s26, v26
    v_add_u32 v17, 27648, v16
    v_add_u32 v18, 55296, v16
    v_add_u32 v19, 82944, v16
    s_mul_i32 s83, s12, 1835008
    s_add_u32 s82, s83, 1835008
    s_mul_i32 s26, s94, 229376
    s_add_u32 s22, s83, s26
    s_mov_b32 s6, 7340032
    s_cmp_ge_u32 s25, 28
    s_cselect_b32 s6, 0, s6
    s_mov_b32 s7, 0x00020000
    s_mov_b32 s4, s68
    s_mov_b32 s5, s69
    s_lshl_b32 s26, s21, 8
    s_lshl_b32 s27, s20, 7
    s_add_u32 s26, s26, s27
    v_lshl_add_u32 v6, v1, 1, s26
    s_lshl_b32 s26, s21, 1
    v_mov_b32 v7, s26
    global_load_ushort v32, v7, s[62:63]
    global_load_ushort v26, v6, s[50:51] nt
    global_load_ushort v27, v6, s[52:53] nt
    global_load_ushort v28, v6, s[54:55] nt
    global_load_ushort v29, v6, s[56:57] nt
    global_load_ushort v30, v6, s[58:59] nt
    global_load_ushort v31, v6, s[60:61] nt
    v_xor_b32 v6, 128, v6
    global_load_ushort v33, v6, s[54:55] nt
    global_load_ushort v34, v6, s[56:57] nt
    global_load_ushort v35, v6, s[58:59] nt
    global_load_ushort v36, v6, s[60:61] nt
    global_load_ushort v38, v7, s[64:65]
    v_lshrrev_b32 v4, 5, v1
    s_lshl_b32 s26, s15, 7
    s_lshl_b32 s27, s12, 5
    s_add_u32 s26, s26, s27
    v_lshl_add_u32 v5, v4, 4, s26
    global_load_dwordx4 v[40:43], v5, s[70:71]
    v_and_b32 v4, 15, v1
    s_lshl_b32 s26, s17, 6
    s_lshl_b32 s27, s12, 4
    s_add_u32 s26, s26, s27
    v_add_u32 v4, s26, v4
    v_lshlrev_b32 v5, 1, v4
    global_load_ushort v44, v5, s[74:75]
    v_lshlrev_b32 v4, 10, v4
    v_lshrrev_b32 v5, 4, v1
    v_lshl_add_u32 v4, v5, 4, v4
    s_lshl_b32 s27, s18, 7
    v_add_u32 v3, s27, v4
    s_mov_b32 s31, s26
    s_add_u32 m0, s13, 8192
    s_nop 0
    buffer_load_dwordx4 v16, s[4:7], s22 offen offset:0 lds
    buffer_load_dwordx4 v17, s[4:7], s22 offen offset:1024 lds
    buffer_load_dwordx4 v18, s[4:7], s22 offen offset:2048 lds
    buffer_load_dwordx4 v19, s[4:7], s22 offen offset:3072 lds
    s_add_u32 s22, s22, 114688
    s_add_u32 m0, s13, 12288
    s_nop 0
    buffer_load_dwordx4 v16, s[4:7], s22 offen offset:0 lds
    buffer_load_dwordx4 v17, s[4:7], s22 offen offset:1024 lds
    buffer_load_dwordx4 v18, s[4:7], s22 offen offset:2048 lds
    buffer_load_dwordx4 v19, s[4:7], s22 offen offset:3072 lds
    s_add_u32 s22, s22, 114688
    s_cmp_eq_u32 s22, s82
    s_cselect_b32 s22, s83, s22
    s_mov_b32 s10, 14680064
    s_mov_b32 s11, 0x00020000
    s_mov_b32 s8, s80
    s_mov_b32 s9, s81
    v_lshrrev_b32 v46, 3, v1
    v_mul_u32_u24 v46, 4096, v46
    v_and_b32 v47, 7, v1
    v_lshl_add_u32 v46, v47, 4, v46
    v_and_b32 v47, 16, v1
    v_lshlrev_b32 v47, 2, v47
    v_xor_b32 v46, v46, v47
    s_lshl_b32 s26, s17, 7
    v_add_u32 v20, s26, v46
    v_add_u32 v21, 31744, v20
    v_add_u32 v22, 63488, v20
    v_add_u32 v23, 95232, v20
    s_mul_i32 s90, s12, 1835008
    s_add_u32 s89, s90, 1835008
    s_mul_i32 s26, s95, 262144
    s_add_u32 s88, s90, s26
    s_mov_b32 s84, s72
    s_mov_b32 s85, s73
    s_mov_b32 s86, 7340032
    s_mov_b32 s87, 0x00020000
    s_mov_b32 s32, 0x3fb8aa3b
    s_mov_b32 s33, 0x32a57060
    s_mov_b32 s34, 0x3f317218
    s_mov_b32 s35, 0x3e22f983
    s_mov_b32 s56, 0x41000000
    s_mov_b32 s57, 0x43000000
    s_mov_b32 s46, 0x3b000000
    s_mov_b32 s47, 0x3727c5ac
    s_mov_b32 s42, 0xbfb8aa3b
    s_mov_b32 s43, 0xbfb8aa3b
    s_mov_b32 s44, 0x3f800000
    s_mov_b32 s45, 0x3f800000
    s_mov_b32 s59, 0xffff0000
    s_mov_b32 s38, 0xbdd2d3e7
    s_mov_b32 s39, 0xbdd2d3e7
    s_mov_b32 s40, 0xc0135761
    s_mov_b32 s41, 0xc0135761
    v_lshrrev_b32 v4, 5, v1
    v_lshlrev_b32 v4, 3, v4
    v_bfe_u32 v5, v1, 2, 2
    v_add_u32 v4, v4, v5
    v_lshlrev_b32 v4, 7, v4
    v_bfe_u32 v5, v1, 4, 1
    v_lshlrev_b32 v5, 1, v5
    v_bfe_u32 v6, v1, 1, 1
    v_add_u32 v5, v5, v6
    v_bfe_u32 v6, v1, 3, 1
    v_lshlrev_b32 v6, 2, v6
    v_xor_b32 v5, v5, v6
    v_lshl_add_u32 v4, v5, 4, v4
    v_and_b32 v6, 1, v1
    v_lshl_add_u32 v4, v6, 3, v4
    v_add_u32 v46, s13, v4
    v_xor_b32 v47, 64, v46
    v_lshrrev_b32 v4, 5, v1
    v_lshlrev_b32 v4, 10, v4
    v_and_b32 v5, 31, v1
    v_lshl_add_u32 v2, v5, 4, v4
    s_lshl_b32 s26, s20, 5
    s_add_u32 s26, s26, s13
    s_add_u32 s26, s26, 32768
    v_lshl_add_u32 v48, v1, 4, s26
    v_bfe_u32 v4, v1, 3, 1
    v_mul_u32_u24 v4, 40992, v4
    v_bfe_u32 v5, v1, 2, 1
    v_mul_u32_u24 v5, 1088, v5
    v_add_u32 v4, v4, v5
    v_lshrrev_b32 v5, 4, v1
    v_lshl_add_u32 v4, v5, 5, v4
    v_and_b32 v5, 3, v1
    v_lshl_add_u32 v4, v5, 3, v4
    v_add_u32 v49, 32768, v4
    v_add_u32 v50, 81920, v49
    v_lshlrev_b32 v51, 4, v1
    v_mov_b32 v52, 0
    s_mul_i32 s58, s19, 81920
    s_add_u32 s26, s58, 24576
    s_lshl_b32 s27, s20, 12
    s_add_u32 s27, s27, s58
    s_add_u32 s58, s58, 35456
    v_lshl_add_u32 v64, v1, 2, s13
    v_xor_b32 v65, 16, v64
    v_xor_b32 v66, 32, v64
    v_xor_b32 v67, 48, v64
    v_xor_b32 v68, 64, v64
    v_xor_b32 v69, 80, v64
    v_xor_b32 v70, 96, v64
    v_xor_b32 v71, 112, v64
    v_xor_b32 v72, 128, v64
    v_xor_b32 v73, 144, v64
    v_xor_b32 v74, 160, v64
    v_xor_b32 v75, 176, v64
    v_xor_b32 v76, 192, v64
    v_xor_b32 v77, 208, v64
    v_xor_b32 v78, 224, v64
    v_xor_b32 v79, 240, v64
    v_and_b32 v56, 15, v1
    v_lshrrev_b32 v57, 4, v1
    v_xor_b32 v58, v56, v57
    v_lshlrev_b32 v58, 4, v58
    v_lshl_add_u32 v58, v56, 8, v58
    v_add_u32 v80, s27, v58
    v_add_u32 v84, s26, v58
    v_xor_b32 v81, 64, v80
    v_xor_b32 v85, 64, v84
    v_xor_b32 v82, 128, v80
    v_xor_b32 v86, 128, v84
    v_xor_b32 v83, 192, v80
    v_xor_b32 v87, 192, v84
    s_waitcnt vmcnt(22)
    v_lshlrev_b32 v56, 16, v8
    v_and_b32 v57, s59, v8
    v_lshlrev_b32 v58, 16, v9
    v_and_b32 v59, s59, v9
    v_lshlrev_b32 v60, 16, v10
    v_and_b32 v61, s59, v10
    v_lshlrev_b32 v62, 16, v11
    v_and_b32 v63, s59, v11
    v_lshlrev_b32 v88, 16, v12
    v_and_b32 v89, s59, v12
    v_lshlrev_b32 v90, 16, v13
    v_and_b32 v91, s59, v13
    v_lshlrev_b32 v92, 16, v14
    v_and_b32 v93, s59, v14
    v_lshlrev_b32 v94, 16, v15
    v_and_b32 v95, s59, v15
    v_pk_add_f32 v[120:121], v[56:57], v[60:61]
    v_pk_add_f32 v[122:123], v[58:59], v[62:63]
    v_pk_add_f32 v[124:125], v[88:89], v[92:93]
    v_pk_add_f32 v[126:127], v[90:91], v[94:95]
    v_pk_add_f32 v[120:121], v[120:121], v[122:123]
    v_pk_add_f32 v[124:125], v[124:125], v[126:127]
    v_add_f32 v54, v120, v121
    v_add_f32 v112, v124, v125
    s_nop 0
    v_add_f32_dpp v54, v54, v54 quad_perm:[1,0,3,2] row_mask:0xf bank_mask:0xf
    v_add_f32_dpp v112, v112, v112 quad_perm:[1,0,3,2] row_mask:0xf bank_mask:0xf
    s_nop 0
    v_add_f32_dpp v54, v54, v54 quad_perm:[2,3,0,1] row_mask:0xf bank_mask:0xf
    v_add_f32_dpp v112, v112, v112 quad_perm:[2,3,0,1] row_mask:0xf bank_mask:0xf
    s_nop 0
    v_add_f32_dpp v54, v54, v54 row_half_mirror row_mask:0xf bank_mask:0xf
    v_add_f32_dpp v112, v112, v112 row_half_mirror row_mask:0xf bank_mask:0xf
    s_nop 0
    v_add_f32_dpp v54, v54, v54 row_mirror row_mask:0xf bank_mask:0xf
    v_add_f32_dpp v112, v112, v112 row_mirror row_mask:0xf bank_mask:0xf
    v_mov_b32 v53, v54
    v_mov_b32 v118, v112
    s_nop 0
    v_permlane16_swap_b32 v54, v53
    v_permlane16_swap_b32 v112, v118
    v_add_f32 v54, v54, v53
    v_add_f32 v112, v112, v118
    v_mov_b32 v53, v54
    v_mov_b32 v118, v112
    s_nop 0
    v_permlane32_swap_b32 v54, v53
    v_permlane32_swap_b32 v112, v118
    v_add_f32 v54, v54, v53
    v_add_f32 v112, v112, v118
    v_mul_f32 v54, s46, v54
    v_mul_f32 v112, s46, v112
    v_pk_add_f32 v[96:97], v[56:57], v[54:55] op_sel_hi:[1,0] neg_lo:[0,1] neg_hi:[0,1]
    v_pk_add_f32 v[104:105], v[88:89], v[112:113] op_sel_hi:[1,0] neg_lo:[0,1] neg_hi:[0,1]
    v_pk_add_f32 v[98:99], v[58:59], v[54:55] op_sel_hi:[1,0] neg_lo:[0,1] neg_hi:[0,1]
    v_pk_add_f32 v[106:107], v[90:91], v[112:113] op_sel_hi:[1,0] neg_lo:[0,1] neg_hi:[0,1]
    v_pk_add_f32 v[100:101], v[60:61], v[54:55] op_sel_hi:[1,0] neg_lo:[0,1] neg_hi:[0,1]
    v_pk_add_f32 v[108:109], v[92:93], v[112:113] op_sel_hi:[1,0] neg_lo:[0,1] neg_hi:[0,1]
    v_pk_add_f32 v[102:103], v[62:63], v[54:55] op_sel_hi:[1,0] neg_lo:[0,1] neg_hi:[0,1]
    v_pk_add_f32 v[110:111], v[94:95], v[112:113] op_sel_hi:[1,0] neg_lo:[0,1] neg_hi:[0,1]
    v_pk_mul_f32 v[120:121], v[96:97], v[96:97]
    v_pk_mul_f32 v[124:125], v[104:105], v[104:105]
    v_pk_fma_f32 v[120:121], v[98:99], v[98:99], v[120:121]
    v_pk_fma_f32 v[124:125], v[106:107], v[106:107], v[124:125]
    v_pk_fma_f32 v[120:121], v[100:101], v[100:101], v[120:121]
    v_pk_fma_f32 v[124:125], v[108:109], v[108:109], v[124:125]
    v_pk_fma_f32 v[120:121], v[102:103], v[102:103], v[120:121]
    v_pk_fma_f32 v[124:125], v[110:111], v[110:111], v[124:125]
    v_add_f32 v114, v120, v121
    v_add_f32 v116, v124, v125
    s_nop 0
    v_add_f32_dpp v114, v114, v114 quad_perm:[1,0,3,2] row_mask:0xf bank_mask:0xf
    v_add_f32_dpp v116, v116, v116 quad_perm:[1,0,3,2] row_mask:0xf bank_mask:0xf
    s_nop 0
    v_add_f32_dpp v114, v114, v114 quad_perm:[2,3,0,1] row_mask:0xf bank_mask:0xf
    v_add_f32_dpp v116, v116, v116 quad_perm:[2,3,0,1] row_mask:0xf bank_mask:0xf
    s_nop 0
    v_add_f32_dpp v114, v114, v114 row_half_mirror row_mask:0xf bank_mask:0xf
    v_add_f32_dpp v116, v116, v116 row_half_mirror row_mask:0xf bank_mask:0xf
    s_nop 0
    v_add_f32_dpp v114, v114, v114 row_mirror row_mask:0xf bank_mask:0xf
    v_add_f32_dpp v116, v116, v116 row_mirror row_mask:0xf bank_mask:0xf
    v_mov_b32 v53, v114
    v_mov_b32 v118, v116
    s_nop 0
    v_permlane16_swap_b32 v114, v53
    v_permlane16_swap_b32 v116, v118
    v_add_f32 v114, v114, v53
    v_add_f32 v116, v116, v118
    v_mov_b32 v53, v114
    v_mov_b32 v118, v116
    s_nop 0
    v_permlane32_swap_b32 v114, v53
    v_permlane32_swap_b32 v116, v118
    v_add_f32 v114, v114, v53
    v_add_f32 v116, v116, v118
    s_add_u32 m0, s13, 16384
    s_nop 0
    buffer_load_dwordx4 v16, s[4:7], s22 offen offset:0 lds
    v_mul_f32 v114, s46, v114
    v_mul_f32 v116, s46, v116
    v_cvt_pk_bf16_f32 v54, v54, v114
    v_cvt_pk_bf16_f32 v112, v112, v116
    v_and_b32 v114, s59, v54
    v_and_b32 v116, s59, v112
    v_lshlrev_b32 v54, 16, v54
    v_lshlrev_b32 v112, 16, v112
    v_add_f32 v114, s47, v114
    v_add_f32 v116, s47, v116
    v_cvt_pk_bf16_f32 v114, v114, v114
    v_cvt_pk_bf16_f32 v116, v116, v116
    v_lshlrev_b32 v114, 16, v114
    v_lshlrev_b32 v116, 16, v116
    v_sqrt_f32 v114, v114
    v_sqrt_f32 v116, v116
    v_pk_add_f32 v[96:97], v[56:57], v[54:55] op_sel_hi:[1,0] neg_lo:[0,1] neg_hi:[0,1]
    v_pk_add_f32 v[104:105], v[88:89], v[112:113] op_sel_hi:[1,0] neg_lo:[0,1] neg_hi:[0,1]
    v_pk_add_f32 v[98:99], v[58:59], v[54:55] op_sel_hi:[1,0] neg_lo:[0,1] neg_hi:[0,1]
    v_pk_add_f32 v[106:107], v[90:91], v[112:113] op_sel_hi:[1,0] neg_lo:[0,1] neg_hi:[0,1]
    v_pk_add_f32 v[100:101], v[60:61], v[54:55] op_sel_hi:[1,0] neg_lo:[0,1] neg_hi:[0,1]
    v_pk_add_f32 v[108:109], v[92:93], v[112:113] op_sel_hi:[1,0] neg_lo:[0,1] neg_hi:[0,1]
    v_pk_add_f32 v[102:103], v[62:63], v[54:55] op_sel_hi:[1,0] neg_lo:[0,1] neg_hi:[0,1]
    v_pk_add_f32 v[110:111], v[94:95], v[112:113] op_sel_hi:[1,0] neg_lo:[0,1] neg_hi:[0,1]
    v_cvt_pk_bf16_f32 v114, v114, v114
    v_cvt_pk_bf16_f32 v116, v116, v116
    v_lshlrev_b32 v114, 16, v114
    v_lshlrev_b32 v116, 16, v116
    v_rcp_f32 v114, v114
    v_rcp_f32 v116, v116
    buffer_load_dwordx4 v17, s[4:7], s22 offen offset:1024 lds
    v_cvt_pk_bf16_f32 v120, v96, v97
    v_cvt_pk_bf16_f32 v124, v104, v105
    v_cvt_pk_bf16_f32 v121, v98, v99
    v_cvt_pk_bf16_f32 v125, v106, v107
    v_cvt_pk_bf16_f32 v122, v100, v101
    v_cvt_pk_bf16_f32 v126, v108, v109
    v_cvt_pk_bf16_f32 v123, v102, v103
    v_cvt_pk_bf16_f32 v127, v110, v111
    v_lshlrev_b32 v96, 16, v120
    v_and_b32 v97, s59, v120
    v_lshlrev_b32 v98, 16, v121
    v_and_b32 v99, s59, v121
    v_lshlrev_b32 v100, 16, v122
    v_and_b32 v101, s59, v122
    v_lshlrev_b32 v102, 16, v123
    v_and_b32 v103, s59, v123
    v_lshlrev_b32 v104, 16, v124
    v_and_b32 v105, s59, v124
    v_lshlrev_b32 v106, 16, v125
    v_and_b32 v107, s59, v125
    v_lshlrev_b32 v108, 16, v126
    v_and_b32 v109, s59, v126
    v_lshlrev_b32 v110, 16, v127
    v_and_b32 v111, s59, v127
    v_pk_mul_f32 v[96:97], v[96:97], v[114:115] op_sel_hi:[1,0]
    v_pk_mul_f32 v[104:105], v[104:105], v[116:117] op_sel_hi:[1,0]
    v_pk_mul_f32 v[98:99], v[98:99], v[114:115] op_sel_hi:[1,0]
    v_pk_mul_f32 v[106:107], v[106:107], v[116:117] op_sel_hi:[1,0]
    v_pk_mul_f32 v[100:101], v[100:101], v[114:115] op_sel_hi:[1,0]
    v_pk_mul_f32 v[108:109], v[108:109], v[116:117] op_sel_hi:[1,0]
    v_pk_mul_f32 v[102:103], v[102:103], v[114:115] op_sel_hi:[1,0]
    v_pk_mul_f32 v[110:111], v[110:111], v[116:117] op_sel_hi:[1,0]
    v_cvt_pk_bf16_f32 v120, v96, v97
    v_cvt_pk_bf16_f32 v124, v104, v105
    v_cvt_pk_bf16_f32 v121, v98, v99
    v_cvt_pk_bf16_f32 v125, v106, v107
    v_cvt_pk_bf16_f32 v122, v100, v101
    v_cvt_pk_bf16_f32 v126, v108, v109
    v_cvt_pk_bf16_f32 v123, v102, v103
    v_cvt_pk_bf16_f32 v127, v110, v111
    ds_write_b128 v48, v[120:123] offset:0
    ds_write_b128 v48, v[124:127] offset:1088
    v_lshlrev_b32 v56, 16, v120
    v_and_b32 v57, s59, v120
    v_lshlrev_b32 v58, 16, v121
    v_and_b32 v59, s59, v121
    v_lshlrev_b32 v60, 16, v122
    v_and_b32 v61, s59, v122
    v_lshlrev_b32 v62, 16, v123
    v_and_b32 v63, s59, v123
    v_lshlrev_b32 v88, 16, v124
    v_and_b32 v89, s59, v124
    v_lshlrev_b32 v90, 16, v125
    v_and_b32 v91, s59, v125
    v_lshlrev_b32 v92, 16, v126
    v_and_b32 v93, s59, v126
    v_lshlrev_b32 v94, 16, v127
    v_and_b32 v95, s59, v127
    v_pk_add_f32 v[120:121], v[56:57], v[60:61]
    v_pk_add_f32 v[122:123], v[58:59], v[62:63]
    v_pk_add_f32 v[124:125], v[88:89], v[92:93]
    v_pk_add_f32 v[126:127], v[90:91], v[94:95]
    v_pk_add_f32 v[120:121], v[120:121], v[122:123]
    v_pk_add_f32 v[124:125], v[124:125], v[126:127]
    v_add_f32 v54, v120, v121
    v_add_f32 v112, v124, v125
    s_nop 0
    v_add_f32_dpp v54, v54, v54 quad_perm:[1,0,3,2] row_mask:0xf bank_mask:0xf
    v_add_f32_dpp v112, v112, v112 quad_perm:[1,0,3,2] row_mask:0xf bank_mask:0xf
    s_nop 0
    v_add_f32_dpp v54, v54, v54 quad_perm:[2,3,0,1] row_mask:0xf bank_mask:0xf
    v_add_f32_dpp v112, v112, v112 quad_perm:[2,3,0,1] row_mask:0xf bank_mask:0xf
    s_nop 0
    v_add_f32_dpp v54, v54, v54 row_half_mirror row_mask:0xf bank_mask:0xf
    v_add_f32_dpp v112, v112, v112 row_half_mirror row_mask:0xf bank_mask:0xf
    s_nop 0
    v_add_f32_dpp v54, v54, v54 row_mirror row_mask:0xf bank_mask:0xf
    v_add_f32_dpp v112, v112, v112 row_mirror row_mask:0xf bank_mask:0xf
    v_mov_b32 v53, v54
    v_mov_b32 v118, v112
    s_nop 0
    v_permlane16_swap_b32 v54, v53
    v_permlane16_swap_b32 v112, v118
    v_add_f32 v54, v54, v53
    v_add_f32 v112, v112, v118
    v_mov_b32 v53, v54
    v_mov_b32 v118, v112
    s_nop 0
    v_permlane32_swap_b32 v54, v53
    v_permlane32_swap_b32 v112, v118
    v_add_f32 v54, v54, v53
    v_add_f32 v112, v112, v118
    v_mul_f32 v54, s46, v54
    v_mul_f32 v112, s46, v112
    v_pk_add_f32 v[96:97], v[56:57], v[54:55] op_sel_hi:[1,0] neg_lo:[0,1] neg_hi:[0,1]
    v_pk_add_f32 v[104:105], v[88:89], v[112:113] op_sel_hi:[1,0] neg_lo:[0,1] neg_hi:[0,1]
    v_pk_add_f32 v[98:99], v[58:59], v[54:55] op_sel_hi:[1,0] neg_lo:[0,1] neg_hi:[0,1]
    v_pk_add_f32 v[106:107], v[90:91], v[112:113] op_sel_hi:[1,0] neg_lo:[0,1] neg_hi:[0,1]
    v_pk_add_f32 v[100:101], v[60:61], v[54:55] op_sel_hi:[1,0] neg_lo:[0,1] neg_hi:[0,1]
    v_pk_add_f32 v[108:109], v[92:93], v[112:113] op_sel_hi:[1,0] neg_lo:[0,1] neg_hi:[0,1]
    v_pk_add_f32 v[102:103], v[62:63], v[54:55] op_sel_hi:[1,0] neg_lo:[0,1] neg_hi:[0,1]
    v_pk_add_f32 v[110:111], v[94:95], v[112:113] op_sel_hi:[1,0] neg_lo:[0,1] neg_hi:[0,1]
    v_pk_mul_f32 v[120:121], v[96:97], v[96:97]
    v_pk_mul_f32 v[124:125], v[104:105], v[104:105]
    v_pk_fma_f32 v[120:121], v[98:99], v[98:99], v[120:121]
    v_pk_fma_f32 v[124:125], v[106:107], v[106:107], v[124:125]
    v_pk_fma_f32 v[120:121], v[100:101], v[100:101], v[120:121]
    v_pk_fma_f32 v[124:125], v[108:109], v[108:109], v[124:125]
    v_pk_fma_f32 v[120:121], v[102:103], v[102:103], v[120:121]
    v_pk_fma_f32 v[124:125], v[110:111], v[110:111], v[124:125]
    v_add_f32 v114, v120, v121
    v_add_f32 v116, v124, v125
    s_nop 0
    v_add_f32_dpp v114, v114, v114 quad_perm:[1,0,3,2] row_mask:0xf bank_mask:0xf
    v_add_f32_dpp v116, v116, v116 quad_perm:[1,0,3,2] row_mask:0xf bank_mask:0xf
    s_nop 0
    v_add_f32_dpp v114, v114, v114 quad_perm:[2,3,0,1] row_mask:0xf bank_mask:0xf
    v_add_f32_dpp v116, v116, v116 quad_perm:[2,3,0,1] row_mask:0xf bank_mask:0xf
    s_nop 0
    v_add_f32_dpp v114, v114, v114 row_half_mirror row_mask:0xf bank_mask:0xf
    v_add_f32_dpp v116, v116, v116 row_half_mirror row_mask:0xf bank_mask:0xf
    s_nop 0
    v_add_f32_dpp v114, v114, v114 row_mirror row_mask:0xf bank_mask:0xf
    v_add_f32_dpp v116, v116, v116 row_mirror row_mask:0xf bank_mask:0xf
    v_mov_b32 v53, v114
    v_mov_b32 v118, v116
    s_nop 0
    v_permlane16_swap_b32 v114, v53
    v_permlane16_swap_b32 v116, v118
    v_add_f32 v114, v114, v53
    v_add_f32 v116, v116, v118
    v_mov_b32 v53, v114
    v_mov_b32 v118, v116
    s_nop 0
    v_permlane32_swap_b32 v114, v53
    v_permlane32_swap_b32 v116, v118
    v_add_f32 v114, v114, v53
    v_add_f32 v116, v116, v118
    v_mul_f32 v114, s46, v114
    v_mul_f32 v116, s46, v116
    v_cvt_pk_bf16_f32 v54, v54, v114
    v_cvt_pk_bf16_f32 v112, v112, v116
    v_and_b32 v114, s59, v54
    v_and_b32 v116, s59, v112
    v_lshlrev_b32 v54, 16, v54
    v_lshlrev_b32 v112, 16, v112
    v_add_f32 v114, s47, v114
    v_add_f32 v116, s47, v116
    v_cvt_pk_bf16_f32 v114, v114, v114
    v_cvt_pk_bf16_f32 v116, v116, v116
    v_lshlrev_b32 v114, 16, v114
    v_lshlrev_b32 v116, 16, v116
    v_sqrt_f32 v114, v114
    v_sqrt_f32 v116, v116
    v_pk_add_f32 v[96:97], v[56:57], v[54:55] op_sel_hi:[1,0] neg_lo:[0,1] neg_hi:[0,1]
    v_pk_add_f32 v[104:105], v[88:89], v[112:113] op_sel_hi:[1,0] neg_lo:[0,1] neg_hi:[0,1]
    v_pk_add_f32 v[98:99], v[58:59], v[54:55] op_sel_hi:[1,0] neg_lo:[0,1] neg_hi:[0,1]
    v_pk_add_f32 v[106:107], v[90:91], v[112:113] op_sel_hi:[1,0] neg_lo:[0,1] neg_hi:[0,1]
    v_pk_add_f32 v[100:101], v[60:61], v[54:55] op_sel_hi:[1,0] neg_lo:[0,1] neg_hi:[0,1]
    v_pk_add_f32 v[108:109], v[92:93], v[112:113] op_sel_hi:[1,0] neg_lo:[0,1] neg_hi:[0,1]
    v_pk_add_f32 v[102:103], v[62:63], v[54:55] op_sel_hi:[1,0] neg_lo:[0,1] neg_hi:[0,1]
    v_pk_add_f32 v[110:111], v[94:95], v[112:113] op_sel_hi:[1,0] neg_lo:[0,1] neg_hi:[0,1]
    v_cvt_pk_bf16_f32 v114, v114, v114
    v_cvt_pk_bf16_f32 v116, v116, v116
    v_lshlrev_b32 v114, 16, v114
    v_lshlrev_b32 v116, 16, v116
    v_rcp_f32 v114, v114
    v_rcp_f32 v116, v116
    v_cvt_pk_bf16_f32 v120, v96, v97
    v_cvt_pk_bf16_f32 v124, v104, v105
    v_cvt_pk_bf16_f32 v121, v98, v99
    v_cvt_pk_bf16_f32 v125, v106, v107
    v_cvt_pk_bf16_f32 v122, v100, v101
    v_cvt_pk_bf16_f32 v126, v108, v109
    v_cvt_pk_bf16_f32 v123, v102, v103
    v_cvt_pk_bf16_f32 v127, v110, v111
    v_lshlrev_b32 v96, 16, v120
    v_and_b32 v97, s59, v120
    v_lshlrev_b32 v98, 16, v121
    v_and_b32 v99, s59, v121
    v_lshlrev_b32 v100, 16, v122
    v_and_b32 v101, s59, v122
    v_lshlrev_b32 v102, 16, v123
    v_and_b32 v103, s59, v123
    v_lshlrev_b32 v104, 16, v124
    v_and_b32 v105, s59, v124
    v_lshlrev_b32 v106, 16, v125
    v_and_b32 v107, s59, v125
    v_lshlrev_b32 v108, 16, v126
    v_and_b32 v109, s59, v126
    v_lshlrev_b32 v110, 16, v127
    v_and_b32 v111, s59, v127
    v_pk_mul_f32 v[96:97], v[96:97], v[114:115] op_sel_hi:[1,0]
    v_pk_mul_f32 v[104:105], v[104:105], v[116:117] op_sel_hi:[1,0]
    v_pk_mul_f32 v[98:99], v[98:99], v[114:115] op_sel_hi:[1,0]
    v_pk_mul_f32 v[106:107], v[106:107], v[116:117] op_sel_hi:[1,0]
    v_pk_mul_f32 v[100:101], v[100:101], v[114:115] op_sel_hi:[1,0]
    v_pk_mul_f32 v[108:109], v[108:109], v[116:117] op_sel_hi:[1,0]
    v_pk_mul_f32 v[102:103], v[102:103], v[114:115] op_sel_hi:[1,0]
    v_pk_mul_f32 v[110:111], v[110:111], v[116:117] op_sel_hi:[1,0]
    v_cvt_pk_bf16_f32 v120, v96, v97
    v_cvt_pk_bf16_f32 v124, v104, v105
    v_cvt_pk_bf16_f32 v121, v98, v99
    v_cvt_pk_bf16_f32 v125, v106, v107
    v_cvt_pk_bf16_f32 v122, v100, v101
    v_cvt_pk_bf16_f32 v126, v108, v109
    v_cvt_pk_bf16_f32 v123, v102, v103
    v_cvt_pk_bf16_f32 v127, v110, v111
    ds_write_b128 v48, v[120:123] offset:2176
    ds_write_b128 v48, v[124:127] offset:3264
    s_waitcnt lgkmcnt(0)
    s_barrier
    s_lshl_b32 s27, s12, 7
    v_add_u32 v49, s27, v49
    v_add_u32 v50, s27, v50
    ds_read_b64_tr_b16 v[192:193], v49 offset:2176
    ds_read_b64_tr_b16 v[194:195], v50 offset:2176
    ds_read_b64_tr_b16 v[196:197], v49 offset:2688
    ds_read_b64_tr_b16 v[198:199], v50 offset:2688
    ds_read_b64_tr_b16 v[200:201], v49 offset:0
    ds_read_b64_tr_b16 v[202:203], v50 offset:0
    ds_read_b64_tr_b16 v[204:205], v49 offset:512
    ds_read_b64_tr_b16 v[206:207], v50 offset:512
    s_lshl_b32 s26, s14, 10
    s_lshl_b32 s27, s12, 18
    s_add_u32 s26, s26, s27
    s_waitcnt lgkmcnt(6)
    buffer_store_dwordx4 v[192:195], v51, s[8:11], s26 offen sc1
    s_add_u32 s26, s26, 0x100000
    s_waitcnt lgkmcnt(4)
    buffer_store_dwordx4 v[196:199], v51, s[8:11], s26 offen sc1
    s_add_u32 s26, s26, 0x100000
    s_waitcnt lgkmcnt(2)
    buffer_store_dwordx4 v[200:203], v51, s[8:11], s26 offen sc1
    s_add_u32 s26, s26, 0x100000
    s_waitcnt lgkmcnt(0)
    buffer_store_dwordx4 v[204:207], v51, s[8:11], s26 offen sc1
    global_load_dwordx2 v[24:25], v52, s[78:79] sc1
    s_cmp_ge_u32 s25, 28
    s_cbranch_scc1 L_dummy
    buffer_load_dwordx4 v18, s[4:7], s22 offen offset:2048 lds
    s_waitcnt vmcnt(19)
    v_lshlrev_b32 v8, 16, v32
    v_mul_f32 v12, s32, v8
    v_lshlrev_b32 v26, 16, v26
    v_fma_f32 v9, v8, s32, -v12
    v_lshlrev_b32 v27, 16, v27
    v_fma_f32 v9, v8, s33, v9
    v_exp_f32 v12, v12
    v_mul_f32 v9, s34, v9
    v_lshlrev_b32 v28, 16, v28
    v_lshlrev_b32 v29, 16, v29
    v_fma_f32 v12, v12, v9, v12
    v_lshlrev_b32 v30, 16, v30
    v_lshlrev_b32 v31, 16, v31
    v_cvt_pk_bf16_f32 v12, v12, v12
    v_lshlrev_b32 v33, 16, v33
    v_lshlrev_b32 v34, 16, v34
    v_lshlrev_b32 v12, 16, v12
    v_lshlrev_b32 v35, 16, v35
    v_lshlrev_b32 v36, 16, v36
    v_mul_f32 v26, v12, v26
    v_mul_f32 v27, v12, v27
    v_mul_f32 v28, v12, v28
    v_mul_f32 v29, v12, v29
    v_mul_f32 v33, v12, v33
    v_mul_f32 v34, v12, v34
    v_mul_f32 v48, s32, v26
    v_mul_f32 v49, s35, v27
    buffer_load_dwordx4 v19, s[4:7], s22 offen offset:3072 lds
    s_add_u32 s22, s22, 114688
    v_mul_f32 v56, v31, v29
    v_mul_f32 v57, v31, v28
    v_mul_f32 v58, v36, v34
    v_mul_f32 v59, v36, v33
    v_fma_f32 v56, v30, v28, -v56
    v_fma_f32 v57, v30, v29, v57
    v_fma_f32 v58, v35, v33, -v58
    v_fma_f32 v59, v35, v34, v59
    v_mul_f32 v50, s56, v48
    v_mul_f32 v51, s56, v49
    v_mul_f32 v54, s57, v48
    v_mul_f32 v55, s57, v49
    v_max3_f32 v8, abs(v56), abs(v57), abs(v58)
    v_fract_f32 v49, v49
    v_max_f32 v8, v8, abs(v59)
    v_exp_f32 v48, v48
    v_fract_f32 v51, v51
    v_max_f32_dpp v8, v8, v8 quad_perm:[1,0,3,2] row_mask:0xf bank_mask:0xf
    v_cos_f32 v60, v49
    s_add_u32 m0, s13, 20480
    s_nop 0
    buffer_load_dwordx4 v16, s[4:7], s22 offen offset:0 lds
    v_fract_f32 v55, v55
    v_max_f32_dpp v8, v8, v8 quad_perm:[2,3,0,1] row_mask:0xf bank_mask:0xf
    v_sin_f32 v61, v49
    v_exp_f32 v50, v50
    v_max_f32_dpp v8, v8, v8 row_half_mirror row_mask:0xf bank_mask:0xf
    v_cos_f32 v62, v51
    v_pk_mul_f32 v[60:61], v[60:61], v[48:49] op_sel_hi:[1,0]
    v_max_f32_dpp v8, v8, v8 row_mirror row_mask:0xf bank_mask:0xf
    v_sin_f32 v63, v51
    v_mov_b32 v9, v8
    v_exp_f32 v54, v54
    s_nop 0
    v_permlane16_swap_b32 v8, v9
    v_cos_f32 v88, v55
    v_pk_mul_f32 v[62:63], v[62:63], v[50:51] op_sel_hi:[1,0]
    v_max_f32 v8, v8, v9
    v_sin_f32 v89, v55
    v_mov_b32 v9, v8
    v_pk_mul_f32 v[90:91], v[60:61], v[60:61] op_sel_hi:[1,0]
    buffer_load_dwordx4 v17, s[4:7], s22 offen offset:1024 lds
    v_permlane32_swap_b32 v8, v9
    v_pk_mul_f32 v[88:89], v[88:89], v[54:55] op_sel_hi:[1,0]
    v_pk_fma_f32 v[90:91], v[60:61], v[60:61], v[90:91] op_sel:[1,1,0] op_sel_hi:[0,1,1] neg_lo:[1,0,0]
    v_max_f32 v8, v8, v9
    v_mov_b32 v13, 0x3c00
    v_and_b32 v8, 0x7f800000, v8
    v_max_u32 v8, 0x00800000, v8
    v_min_u32 v14, 0x7e800000, v8
    v_sub_u32 v9, 0x7f000000, v14
    v_pk_mul_f32 v[56:57], v[56:57], v[8:9] op_sel:[0,1] neg_hi:[0,1]
    v_pk_mul_f32 v[26:27], v[62:63], v[62:63] op_sel_hi:[1,0]
    v_pk_mul_f32 v[28:29], v[88:89], v[88:89] op_sel_hi:[1,0]
    v_pk_mul_f32 v[30:31], v[90:91], v[60:61] op_sel_hi:[1,0]
    v_pk_mul_f32 v[32:33], v[90:91], v[90:91] op_sel_hi:[1,0]
    v_pk_mul_f32 v[34:35], v[56:57], v[62:63] op_sel_hi:[1,0]
    v_pk_mul_f32 v[48:49], v[56:57], v[88:89] op_sel_hi:[1,0]
    v_cvt_pk_f16_f32 v12, v60, v61
    v_cvt_pk_f16_f32 v36, v90, v91
    v_cvt_pk_f16_f32 v50, v56, v57
    v_pk_fma_f32 v[26:27], v[62:63], v[62:63], v[26:27] op_sel:[1,1,0] op_sel_hi:[0,1,1] neg_lo:[1,0,0]
    v_pk_fma_f32 v[28:29], v[88:89], v[88:89], v[28:29] op_sel:[1,1,0] op_sel_hi:[0,1,1] neg_lo:[1,0,0]
    v_pk_fma_f32 v[30:31], v[90:91], v[60:61], v[30:31] op_sel:[1,1,0] op_sel_hi:[0,1,1] neg_lo:[1,0,0]
    buffer_load_dwordx4 v18, s[4:7], s22 offen offset:2048 lds
    v_pk_fma_f32 v[32:33], v[90:91], v[90:91], v[32:33] op_sel:[1,1,0] op_sel_hi:[0,1,1] neg_lo:[1,0,0]
    v_pk_fma_f32 v[34:35], v[56:57], v[62:63], v[34:35] op_sel:[1,1,0] op_sel_hi:[0,1,1] neg_hi:[1,0,0]
    v_pk_fma_f32 v[48:49], v[56:57], v[88:89], v[48:49] op_sel:[1,1,0] op_sel_hi:[0,1,1] neg_hi:[1,0,0]
    v_pk_mul_f32 v[54:55], v[26:27], v[26:27] op_sel_hi:[1,0]
    v_pk_mul_f32 v[58:59], v[28:29], v[28:29] op_sel_hi:[1,0]
    v_pk_mul_f32 v[92:93], v[56:57], v[26:27] op_sel_hi:[1,0]
    v_pk_mul_f32 v[94:95], v[34:35], v[26:27] op_sel_hi:[1,0]
    v_pk_mul_f32 v[96:97], v[34:35], v[88:89] op_sel_hi:[1,0]
    v_pk_mul_f32 v[98:99], v[32:33], v[60:61] op_sel_hi:[1,0]
    v_pk_mul_f32 v[100:101], v[32:33], v[90:91] op_sel_hi:[1,0]
    v_pk_mul_f32 v[102:103], v[32:33], v[30:31] op_sel_hi:[1,0]
    v_pk_mul_f32 v[104:105], v[28:29], v[90:91] op_sel_hi:[1,0]
    v_pk_mul_f32 v[106:107], v[28:29], v[32:33] op_sel_hi:[1,0]
    v_cvt_pk_f16_f32 v51, v48, v49
    v_cvt_pk_f16_f32 v53, v28, v29
    v_cvt_pk_f16_f32 v108, v30, v31
    v_cvt_pk_f16_f32 v109, v32, v33
    v_cvt_pk_f16_f32 v110, v34, v35
    v_pk_fma_f32 v[54:55], v[26:27], v[26:27], v[54:55] op_sel:[1,1,0] op_sel_hi:[0,1,1] neg_lo:[1,0,0]
    v_pk_fma_f32 v[58:59], v[28:29], v[28:29], v[58:59] op_sel:[1,1,0] op_sel_hi:[0,1,1] neg_lo:[1,0,0]
    v_pk_fma_f32 v[92:93], v[56:57], v[26:27], v[92:93] op_sel:[1,1,0] op_sel_hi:[0,1,1] neg_hi:[1,0,0]
    v_pk_fma_f32 v[94:95], v[34:35], v[26:27], v[94:95] op_sel:[1,1,0] op_sel_hi:[0,1,1] neg_hi:[1,0,0]
    v_pk_fma_f32 v[96:97], v[34:35], v[88:89], v[96:97] op_sel:[1,1,0] op_sel_hi:[0,1,1] neg_hi:[1,0,0]
    buffer_load_dwordx4 v19, s[4:7], s22 offen offset:3072 lds
    s_add_u32 s22, s22, 114688
    s_cmp_eq_u32 s22, s82
    s_cselect_b32 s22, s83, s22
    v_pk_fma_f32 v[98:99], v[32:33], v[60:61], v[98:99] op_sel:[1,1,0] op_sel_hi:[0,1,1] neg_lo:[1,0,0]
    v_pk_fma_f32 v[100:101], v[32:33], v[90:91], v[100:101] op_sel:[1,1,0] op_sel_hi:[0,1,1] neg_lo:[1,0,0]
    v_pk_fma_f32 v[102:103], v[32:33], v[30:31], v[102:103] op_sel:[1,1,0] op_sel_hi:[0,1,1] neg_lo:[1,0,0]
    v_pk_fma_f32 v[104:105], v[28:29], v[90:91], v[104:105] op_sel:[1,1,0] op_sel_hi:[0,1,1] neg_lo:[1,0,0]
    v_pk_fma_f32 v[106:107], v[28:29], v[32:33], v[106:107] op_sel:[1,1,0] op_sel_hi:[0,1,1] neg_lo:[1,0,0]
    ds_write2st64_b32 v64, v51, v50 offset0:16 offset1:0
    v_pk_mul_f32 v[50:51], v[56:57], v[54:55] op_sel_hi:[1,0]
    v_pk_mul_f32 v[112:113], v[34:35], v[54:55] op_sel_hi:[1,0]
    v_pk_mul_f32 v[114:115], v[92:93], v[54:55] op_sel_hi:[1,0]
    v_pk_mul_f32 v[116:117], v[94:95], v[54:55] op_sel_hi:[1,0]
    v_pk_mul_f32 v[118:119], v[92:93], v[88:89] op_sel_hi:[1,0]
    v_pk_mul_f32 v[120:121], v[94:95], v[88:89] op_sel_hi:[1,0]
    v_pk_mul_f32 v[122:123], v[58:59], v[28:29] op_sel_hi:[1,0]
    v_pk_mul_f32 v[124:125], v[58:59], v[58:59] op_sel_hi:[1,0]
    v_pk_mul_f32 v[126:127], v[58:59], v[32:33] op_sel_hi:[1,0]
    v_pk_mul_f32 v[128:129], v[28:29], v[100:101] op_sel_hi:[1,0]
    v_cvt_pk_f16_f32 v111, v58, v59
    v_cvt_pk_f16_f32 v130, v96, v97
    v_cvt_pk_f16_f32 v131, v104, v105
    v_cvt_pk_f16_f32 v132, v106, v107
    v_cvt_pk_f16_f32 v133, v92, v93
    v_cvt_pk_f16_f32 v134, v94, v95
    v_cvt_pk_f16_f32 v135, v98, v99
    v_cvt_pk_f16_f32 v136, v100, v101
    v_cvt_pk_f16_f32 v137, v102, v103
    v_pk_fma_f32 v[50:51], v[56:57], v[54:55], v[50:51] op_sel:[1,1,0] op_sel_hi:[0,1,1] neg_hi:[1,0,0]
    s_waitcnt vmcnt(19)
    ds_read_b64_tr_b16 a[0:1], v46 offset:8192
    ds_read_b64_tr_b16 a[2:3], v46 offset:8704
    ds_read_b64_tr_b16 a[4:5], v47 offset:8192
    ds_read_b64_tr_b16 a[6:7], v47 offset:8704
    v_pk_fma_f32 v[112:113], v[34:35], v[54:55], v[112:113] op_sel:[1,1,0] op_sel_hi:[0,1,1] neg_hi:[1,0,0]
    v_pk_fma_f32 v[114:115], v[92:93], v[54:55], v[114:115] op_sel:[1,1,0] op_sel_hi:[0,1,1] neg_hi:[1,0,0]
    v_pk_fma_f32 v[116:117], v[94:95], v[54:55], v[116:117] op_sel:[1,1,0] op_sel_hi:[0,1,1] neg_hi:[1,0,0]
    v_pk_fma_f32 v[118:119], v[92:93], v[88:89], v[118:119] op_sel:[1,1,0] op_sel_hi:[0,1,1] neg_hi:[1,0,0]
    v_pk_fma_f32 v[120:121], v[94:95], v[88:89], v[120:121] op_sel:[1,1,0] op_sel_hi:[0,1,1] neg_hi:[1,0,0]
    v_pk_fma_f32 v[122:123], v[58:59], v[28:29], v[122:123] op_sel:[1,1,0] op_sel_hi:[0,1,1] neg_lo:[1,0,0]
    v_pk_fma_f32 v[124:125], v[58:59], v[58:59], v[124:125] op_sel:[1,1,0] op_sel_hi:[0,1,1] neg_lo:[1,0,0]
    v_pk_fma_f32 v[126:127], v[58:59], v[32:33], v[126:127] op_sel:[1,1,0] op_sel_hi:[0,1,1] neg_lo:[1,0,0]
    v_pk_fma_f32 v[128:129], v[28:29], v[100:101], v[128:129] op_sel:[1,1,0] op_sel_hi:[0,1,1] neg_lo:[1,0,0]
    ds_write2st64_b32 v64, v111, v13 offset0:112 offset1:96
    ds_write2st64_b32 v65, v130, v110 offset0:17 offset1:1
    ds_write_b32 v73, v131 offset:26880
    ds_write_b32 v74, v132 offset:27136
    v_pk_mul_f32 v[110:111], v[50:51], v[54:55] op_sel_hi:[1,0]
    v_pk_mul_f32 v[130:131], v[112:113], v[54:55] op_sel_hi:[1,0]
    v_pk_mul_f32 v[138:139], v[114:115], v[54:55] op_sel_hi:[1,0]
    v_pk_mul_f32 v[140:141], v[116:117], v[54:55] op_sel_hi:[1,0]
    v_pk_mul_f32 v[142:143], v[50:51], v[88:89] op_sel_hi:[1,0]
    v_pk_mul_f32 v[144:145], v[112:113], v[88:89] op_sel_hi:[1,0]
    v_pk_mul_f32 v[146:147], v[114:115], v[88:89] op_sel_hi:[1,0]
    v_pk_mul_f32 v[148:149], v[116:117], v[88:89] op_sel_hi:[1,0]
    v_pk_mul_f32 v[150:151], v[122:123], v[32:33] op_sel_hi:[1,0]
    v_pk_mul_f32 v[152:153], v[124:125], v[28:29] op_sel_hi:[1,0]
    v_pk_mul_f32 v[154:155], v[124:125], v[58:59] op_sel_hi:[1,0]
    v_pk_mul_f32 v[156:157], v[124:125], v[122:123] op_sel_hi:[1,0]
    s_waitcnt vmcnt(17)
    ds_read_b64_tr_b16 a[8:9], v46 offset:10240
    ds_read_b64_tr_b16 a[10:11], v46 offset:10752
    ds_read_b64_tr_b16 a[12:13], v47 offset:10240
    ds_read_b64_tr_b16 a[14:15], v47 offset:10752
    v_pk_mul_f32 v[158:159], v[124:125], v[124:125] op_sel_hi:[1,0]
    v_cvt_pk_f16_f32 v13, v118, v119
    v_cvt_pk_f16_f32 v132, v120, v121
    v_cvt_pk_f16_f32 v160, v122, v123
    v_cvt_pk_f16_f32 v161, v124, v125
    v_cvt_pk_f16_f32 v162, v126, v127
    v_cvt_pk_f16_f32 v163, v128, v129
    v_cvt_pk_f16_f32 v164, v50, v51
    v_cvt_pk_f16_f32 v165, v112, v113
    v_cvt_pk_f16_f32 v166, v114, v115
    v_cvt_pk_f16_f32 v167, v116, v117
    v_pk_fma_f32 v[110:111], v[50:51], v[54:55], v[110:111] op_sel:[1,1,0] op_sel_hi:[0,1,1] neg_hi:[1,0,0]
    v_pk_fma_f32 v[130:131], v[112:113], v[54:55], v[130:131] op_sel:[1,1,0] op_sel_hi:[0,1,1] neg_hi:[1,0,0]
    v_pk_fma_f32 v[138:139], v[114:115], v[54:55], v[138:139] op_sel:[1,1,0] op_sel_hi:[0,1,1] neg_hi:[1,0,0]
    v_pk_fma_f32 v[140:141], v[116:117], v[54:55], v[140:141] op_sel:[1,1,0] op_sel_hi:[0,1,1] neg_hi:[1,0,0]
    v_pk_fma_f32 v[142:143], v[50:51], v[88:89], v[142:143] op_sel:[1,1,0] op_sel_hi:[0,1,1] neg_hi:[1,0,0]
    v_pk_fma_f32 v[144:145], v[112:113], v[88:89], v[144:145] op_sel:[1,1,0] op_sel_hi:[0,1,1] neg_hi:[1,0,0]
    v_pk_fma_f32 v[146:147], v[114:115], v[88:89], v[146:147] op_sel:[1,1,0] op_sel_hi:[0,1,1] neg_hi:[1,0,0]
    v_pk_fma_f32 v[148:149], v[116:117], v[88:89], v[148:149] op_sel:[1,1,0] op_sel_hi:[0,1,1] neg_hi:[1,0,0]
    v_pk_fma_f32 v[150:151], v[122:123], v[32:33], v[150:151] op_sel:[1,1,0] op_sel_hi:[0,1,1] neg_lo:[1,0,0]
    v_pk_fma_f32 v[152:153], v[124:125], v[28:29], v[152:153] op_sel:[1,1,0] op_sel_hi:[0,1,1] neg_lo:[1,0,0]
    v_pk_fma_f32 v[154:155], v[124:125], v[58:59], v[154:155] op_sel:[1,1,0] op_sel_hi:[0,1,1] neg_lo:[1,0,0]
    v_pk_fma_f32 v[156:157], v[124:125], v[122:123], v[156:157] op_sel:[1,1,0] op_sel_hi:[0,1,1] neg_lo:[1,0,0]
    v_pk_fma_f32 v[158:159], v[124:125], v[124:125], v[158:159] op_sel:[1,1,0] op_sel_hi:[0,1,1] neg_lo:[1,0,0]
    s_waitcnt lgkmcnt(8)
    s_add_u32 m0, s13, 8192
    s_nop 0
    buffer_load_dwordx4 v16, s[4:7], s22 offen offset:0 lds
    ds_write2st64_b32 v66, v13, v133 offset0:18 offset1:2
    ds_write2st64_b32 v67, v132, v134 offset0:19 offset1:3
    ds_write2st64_b32 v66, v160, v36 offset0:114 offset1:98
    ds_write2st64_b32 v68, v161, v109 offset0:116 offset1:100
    ds_write2st64_b32 v65, v162, v12 offset0:113 offset1:97
    ds_write_b32 v75, v163 offset:27392
    v_pk_mul_f32 v[12:13], v[110:111], v[54:55] op_sel_hi:[1,0]
    v_pk_mul_f32 v[132:133], v[130:131], v[54:55] op_sel_hi:[1,0]
    v_pk_mul_f32 v[160:161], v[138:139], v[54:55] op_sel_hi:[1,0]
    v_pk_mul_f32 v[162:163], v[140:141], v[54:55] op_sel_hi:[1,0]
    v_pk_mul_f32 v[168:169], v[110:111], v[88:89] op_sel_hi:[1,0]
    v_pk_mul_f32 v[170:171], v[130:131], v[88:89] op_sel_hi:[1,0]
    v_pk_mul_f32 v[172:173], v[138:139], v[88:89] op_sel_hi:[1,0]
    v_pk_mul_f32 v[174:175], v[140:141], v[88:89] op_sel_hi:[1,0]
    v_cvt_pk_f16_f32 v36, v142, v143
    v_cvt_pk_f16_f32 v109, v144, v145
    v_cvt_pk_f16_f32 v134, v146, v147
    v_cvt_pk_f16_f32 v176, v148, v149
    v_cvt_pk_f16_f32 v177, v150, v151
    v_cvt_pk_f16_f32 v178, v152, v153
    v_cvt_pk_f16_f32 v179, v154, v155
    v_cvt_pk_f16_f32 v180, v156, v157
    buffer_load_dwordx4 v17, s[4:7], s22 offen offset:1024 lds
    v_cvt_pk_f16_f32 v181, v158, v159
    v_cvt_pk_f16_f32 v182, v110, v111
    v_cvt_pk_f16_f32 v183, v130, v131
    v_cvt_pk_f16_f32 v184, v138, v139
    v_cvt_pk_f16_f32 v185, v140, v141
    v_pk_fma_f32 v[12:13], v[110:111], v[54:55], v[12:13] op_sel:[1,1,0] op_sel_hi:[0,1,1] neg_hi:[1,0,0]
    v_pk_fma_f32 v[132:133], v[130:131], v[54:55], v[132:133] op_sel:[1,1,0] op_sel_hi:[0,1,1] neg_hi:[1,0,0]
    v_pk_fma_f32 v[160:161], v[138:139], v[54:55], v[160:161] op_sel:[1,1,0] op_sel_hi:[0,1,1] neg_hi:[1,0,0]
    v_pk_fma_f32 v[162:163], v[140:141], v[54:55], v[162:163] op_sel:[1,1,0] op_sel_hi:[0,1,1] neg_hi:[1,0,0]
    v_pk_fma_f32 v[168:169], v[110:111], v[88:89], v[168:169] op_sel:[1,1,0] op_sel_hi:[0,1,1] neg_hi:[1,0,0]
    v_pk_fma_f32 v[170:171], v[130:131], v[88:89], v[170:171] op_sel:[1,1,0] op_sel_hi:[0,1,1] neg_hi:[1,0,0]
    v_pk_fma_f32 v[172:173], v[138:139], v[88:89], v[172:173] op_sel:[1,1,0] op_sel_hi:[0,1,1] neg_hi:[1,0,0]
    v_pk_fma_f32 v[174:175], v[140:141], v[88:89], v[174:175] op_sel:[1,1,0] op_sel_hi:[0,1,1] neg_hi:[1,0,0]
    ds_write2st64_b32 v68, v36, v164 offset0:20 offset1:4
    ds_write2st64_b32 v69, v109, v165 offset0:21 offset1:5
    ds_write2st64_b32 v70, v134, v166 offset0:22 offset1:6
    ds_write2st64_b32 v71, v176, v167 offset0:23 offset1:7
    ds_write2st64_b32 v67, v177, v108 offset0:115 offset1:99
    ds_write2st64_b32 v69, v178, v135 offset0:117 offset1:101
    ds_write2st64_b32 v70, v179, v136 offset0:118 offset1:102
    ds_write2st64_b32 v71, v180, v137 offset0:119 offset1:103
    ds_write2st64_b32 v72, v181, v53 offset0:120 offset1:104
    v_pk_mul_f32 v[108:109], v[12:13], v[88:89] op_sel_hi:[1,0]
    v_pk_mul_f32 v[134:135], v[132:133], v[88:89] op_sel_hi:[1,0]
    v_pk_mul_f32 v[136:137], v[160:161], v[88:89] op_sel_hi:[1,0]
    v_pk_mul_f32 v[164:165], v[162:163], v[88:89] op_sel_hi:[1,0]
    s_waitcnt vmcnt(17)
    ds_read_b64_tr_b16 a[16:17], v46 offset:12288
    ds_read_b64_tr_b16 a[18:19], v46 offset:12800
    ds_read_b64_tr_b16 a[20:21], v47 offset:12288
    ds_read_b64_tr_b16 a[22:23], v47 offset:12800
    v_cvt_pk_f16_f32 v36, v168, v169
    v_cvt_pk_f16_f32 v53, v170, v171
    v_cvt_pk_f16_f32 v166, v172, v173
    v_cvt_pk_f16_f32 v167, v174, v175
    v_cvt_pk_f16_f32 v176, v12, v13
    v_cvt_pk_f16_f32 v177, v132, v133
    v_cvt_pk_f16_f32 v178, v160, v161
    v_cvt_pk_f16_f32 v179, v162, v163
    v_pk_fma_f32 v[108:109], v[12:13], v[88:89], v[108:109] op_sel:[1,1,0] op_sel_hi:[0,1,1] neg_hi:[1,0,0]
    v_pk_fma_f32 v[134:135], v[132:133], v[88:89], v[134:135] op_sel:[1,1,0] op_sel_hi:[0,1,1] neg_hi:[1,0,0]
    v_pk_fma_f32 v[136:137], v[160:161], v[88:89], v[136:137] op_sel:[1,1,0] op_sel_hi:[0,1,1] neg_hi:[1,0,0]
    v_pk_fma_f32 v[164:165], v[162:163], v[88:89], v[164:165] op_sel:[1,1,0] op_sel_hi:[0,1,1] neg_hi:[1,0,0]
    ds_write2st64_b32 v72, v36, v182 offset0:24 offset1:8
    ds_write2st64_b32 v73, v53, v183 offset0:25 offset1:9
    ds_write2st64_b32 v74, v166, v184 offset0:26 offset1:10
    ds_write2st64_b32 v75, v167, v185 offset0:27 offset1:11
    v_cvt_pk_f16_f32 v36, v108, v109
    v_cvt_pk_f16_f32 v53, v134, v135
    v_cvt_pk_f16_f32 v166, v136, v137
    v_cvt_pk_f16_f32 v167, v164, v165
    ds_write2st64_b32 v76, v36, v176 offset0:28 offset1:12
    ds_write2st64_b32 v77, v53, v177 offset0:29 offset1:13
    ds_write2st64_b32 v78, v166, v178 offset0:30 offset1:14
    ds_write2st64_b32 v79, v167, v179 offset0:31 offset1:15
    s_waitcnt lgkmcnt(15)
    buffer_load_dwordx4 v18, s[4:7], s22 offen offset:2048 lds
    s_waitcnt vmcnt(9) lgkmcnt(0)
    v_cmp_eq_u32 vcc, 0, v25
    s_cbranch_vccz L_zp1_ok
    s_mov_b32 s26, 0
L_zp1:
    global_load_dwordx2 v[24:25], v52, s[78:79] sc1
    s_add_u32 s26, s26, 1
    s_cmp_ge_u32 s26, 0x8000
    s_cbranch_scc1 L_zp1_ok
    s_waitcnt vmcnt(0)
    v_cmp_eq_u32 vcc, 0, v25
    s_cbranch_vccnz L_zp1
L_zp1_ok:
    v_readfirstlane_b32 s100, v24
    v_readfirstlane_b32 s101, v25
    s_barrier
    s_cmp_lg_u32 s12, 0
    s_cbranch_scc1 L_fl1
    s_lshl_b32 s26, s14, 3
    s_add_u32 s26, s26, 12582912
    v_mov_b32 v8, s26
    s_or_b32 s26, s100, 1
    v_mov_b32 v10, s26
    v_mov_b32 v11, s101
    s_mov_b64 exec, 1
    global_store_dwordx2 v8, v[10:11], s[80:81] sc1
    s_mov_b64 exec, -1
L_fl1:
    ds_read_b128 v[48:51], v80 offset:0
    ds_read_b128 v[52:55], v84 offset:0
    ds_read_b128 v[56:59], v84 offset:4096
    ds_read_b128 v[60:63], v81 offset:0
    ds_read_b128 v[64:67], v85 offset:0
    ds_read_b128 v[68:71], v85 offset:4096
    s_lshl_b32 s26, s12, 9
    s_add_u32 s26, s26, 12582912
    v_lshl_add_u32 v8, v1, 3, s26
    s_lshl_b32 s26, s16, 18
    s_lshl_b32 s27, s15, 13
    s_add_u32 s26, s26, s27
    s_add_u32 s26, s26, 4194304
    s_cmp_ge_u32 s25, 28
    s_cselect_b32 s26, 13631488, s26
    s_lshl_b32 s27, s12, 11
    s_add_u32 s26, s26, s27
    v_add_u32 v9, s26, v2
    v_and_b32 v10, 31, v1
    v_lshrrev_b32 v11, 5, v1
    v_xor_b32 v11, v11, v10
    v_and_b32 v11, 7, v11
    v_lshlrev_b32 v10, 8, v10
    v_lshl_add_u32 v10, v11, 4, v10
    s_add_u32 s26, s13, 18432
    v_add_u32 v28, s26, v10
    v_xor_b32 v29, 32, v28
    v_xor_b32 v30, 64, v28
    v_xor_b32 v31, 96, v28
    v_lshrrev_b32 v10, 5, v1
    v_lshlrev_b32 v10, 1, v10
    s_lshl_b32 s26, s12, 2
    v_add_u32 v10, s26, v10
    v_and_b32 v11, 7, v1
    v_xor_b32 v10, v10, v11
    v_and_b32 v11, 31, v1
    v_lshlrev_b32 v11, 8, v11
    v_lshl_add_u32 v10, v10, 4, v11
    v_add_u32 v32, 18432, v10
    v_xor_b32 v33, 16, v32
    v_add_u32 v34, 81920, v32
    v_add_u32 v35, 81920, v33
    v_mov_b32 v10, s40
    v_mov_b32 v11, s40
    s_waitcnt vmcnt(25)
    v_lshlrev_b32 v72, 16, v40
    v_and_b32 v73, s59, v40
    v_lshlrev_b32 v74, 16, v41
    v_and_b32 v75, s59, v41
    v_lshlrev_b32 v76, 16, v42
    v_and_b32 v77, s59, v42
    v_lshlrev_b32 v78, 16, v43
    v_and_b32 v79, s59, v43
    s_add_u32 m0, s13, 8192
    s_nop 0
    buffer_load_dwordx4 v19, s[4:7], s22 offen offset:3072 lds
    s_add_u32 s22, s22, 114688
    ds_read_b128 v[88:91], v82 offset:0
    ds_read_b128 v[92:95], v86 offset:0
    ds_read_b128 v[96:99], v86 offset:4096
    ds_read_b128 v[100:103], v83 offset:0
    ds_read_b128 v[104:107], v87 offset:0
    ds_read_b128 v[108:111], v87 offset:4096
    s_waitcnt vmcnt(17)
    ds_read_b64_tr_b16 a[24:25], v46 offset:14336
    ds_read_b64_tr_b16 a[26:27], v46 offset:14848
    ds_read_b64_tr_b16 a[28:29], v47 offset:14336
    ds_read_b64_tr_b16 a[30:31], v47 offset:14848
    v_and_b32 v128, 15, v1
    v_lshrrev_b32 v129, 4, v1
    v_mov_b32 v130, 1025
    v_lshlrev_b32 v131, 1, v128
    v_add_u32 v131, 240, v131
    s_waitcnt lgkmcnt(15)
    s_add_u32 m0, s13, 12288
    s_nop 0
    buffer_load_dwordx4 v16, s[4:7], s22 offen offset:0 lds
    s_mov_b32 s26, 0xfff0fff
    s_mov_b32 s27, s26
    v_cndmask_b32 v131, v130, v131, s[26:27]
    s_mov_b32 s26, 0xff00ff
    s_mov_b32 s27, s26
    v_cndmask_b32 v12, v131, v128, s[26:27]
    buffer_load_dwordx4 v17, s[4:7], s22 offen offset:1024 lds
    v_lshlrev_b32 v131, 8, v128
    s_mov_b32 s26, 0x1ff01ff
    s_mov_b32 s27, s26
    v_cndmask_b32 v131, v130, v131, s[26:27]
    v_lshrrev_b32 v132, 1, v128
    v_lshlrev_b32 v132, 8, v132
    v_and_b32 v133, 1, v128
    v_lshl_add_u32 v132, v133, 2, v132
    v_add_u32 v132, 512, v132
    s_waitcnt vmcnt(17)
    ds_read_b64_tr_b16 a[32:33], v46 offset:16384
    ds_read_b64_tr_b16 a[34:35], v46 offset:16896
    ds_read_b64_tr_b16 a[36:37], v47 offset:16384
    ds_read_b64_tr_b16 a[38:39], v47 offset:16896
    s_waitcnt lgkmcnt(15)
    v_mfma_f32_16x16x32_f16 v[112:115], v[48:51], v[52:55], 0
    v_mfma_f32_16x16x32_f16 v[116:119], v[48:51], v[56:59], 0
    s_waitcnt lgkmcnt(4)
    buffer_load_dwordx4 v18, s[4:7], s22 offen offset:2048 lds
    buffer_load_dwordx4 v19, s[4:7], s22 offen offset:3072 lds
    s_add_u32 s22, s22, 114688
    s_cmp_eq_u32 s22, s82
    s_cselect_b32 s22, s83, s22
    ds_read_b128 v[48:51], v80 offset:40960
    ds_read_b128 v[52:55], v84 offset:40960
    ds_read_b128 v[56:59], v84 offset:45056
    s_mov_b32 s26, 0xf000f
    s_mov_b32 s27, s26
    v_cndmask_b32 v13, v131, v132, s[26:27]
    s_mul_i32 s27, s20, 288
    s_add_u32 s27, s27, s58
    v_mul_u32_u24 v129, 72, v129
    v_add_u32 v129, s27, v129
    s_waitcnt vmcnt(12)
    ds_read_b64_tr_b16 a[40:41], v46 offset:18432
    ds_read_b64_tr_b16 a[42:43], v46 offset:18944
    ds_read_b64_tr_b16 a[44:45], v47 offset:18432
    ds_read_b64_tr_b16 a[46:47], v47 offset:18944
    v_lshrrev_b32 v130, 4, v12
    v_lshl_add_u32 v12, v12, 1, v129
    v_lshl_add_u32 v12, v130, 2, v12
    v_lshrrev_b32 v130, 4, v13
    v_lshl_add_u32 v13, v13, 1, v129
    v_lshl_add_u32 v13, v130, 2, v13
    s_waitcnt lgkmcnt(7)
    s_add_u32 m0, s13, 16384
    s_nop 0
    buffer_load_dwordx4 v16, s[4:7], s22 offen offset:0 lds
    s_waitcnt lgkmcnt(15)
    v_mfma_f32_16x16x32_f16 v[112:115], v[60:63], v[64:67], v[112:115]
    v_mfma_f32_16x16x32_f16 v[116:119], v[60:63], v[68:71], v[116:119]
    buffer_load_dwordx4 v17, s[4:7], s22 offen offset:1024 lds
    s_waitcnt vmcnt(12)
    ds_read_b64_tr_b16 a[48:49], v46 offset:20480
    ds_read_b64_tr_b16 a[50:51], v46 offset:20992
    ds_read_b64_tr_b16 a[52:53], v47 offset:20480
    ds_read_b64_tr_b16 a[54:55], v47 offset:20992
    ds_read_b128 v[60:63], v81 offset:40960
    ds_read_b128 v[64:67], v85 offset:40960
    ds_read_b128 v[68:71], v85 offset:45056
    s_lshl_b32 s27, s20, 10
    v_lshl_add_u32 v132, v1, 4, s27
    v_lshlrev_b32 v36, 1, v132
    v_sub_u32 v132, 2047, v132
    v_cvt_f32_u32 v128, v132
    s_waitcnt lgkmcnt(7)
    buffer_load_dwordx4 v18, s[4:7], s22 offen offset:2048 lds
    v_add_f32 v129, -1.0, v128
    v_mov_b32 v130, -2.0
    v_mov_b32 v132, 513.0
    v_mov_b32 v133, s58
    v_cvt_pk_bf16_f32 v131, v128, v129
    v_pk_add_f32 v[128:129], v[128:129], v[130:131] op_sel_hi:[1,0]
    v_and_b32 v27, s59, v131
    v_lshlrev_b32 v26, 16, v131
    buffer_load_dwordx4 v19, s[4:7], s22 offen offset:3072 lds
    s_add_u32 s22, s22, 114688
    s_waitcnt vmcnt(12)
    ds_read_b64_tr_b16 a[56:57], v46 offset:22528
    ds_read_b64_tr_b16 a[58:59], v46 offset:23040
    ds_read_b64_tr_b16 a[60:61], v47 offset:22528
    ds_read_b64_tr_b16 a[62:63], v47 offset:23040
    s_waitcnt lgkmcnt(15)
    v_mfma_f32_16x16x32_f16 v[112:115], v[88:91], v[92:95], v[112:115]
    v_mfma_f32_16x16x32_f16 v[116:119], v[88:91], v[96:99], v[116:119]
    s_waitcnt lgkmcnt(7)
    s_add_u32 m0, s13, 20480
    s_nop 0
    buffer_load_dwordx4 v16, s[4:7], s22 offen offset:0 lds
    ds_read_b128 v[88:91], v82 offset:40960
    ds_read_b128 v[92:95], v86 offset:40960
    ds_read_b128 v[96:99], v86 offset:45056
    buffer_load_dwordx4 v17, s[4:7], s22 offen offset:1024 lds
    v_cvt_u32_f32 v26, v26
    v_cvt_u32_f32 v27, v27
    v_lshrrev_b32 v134, 4, v26
    v_lshrrev_b32 v135, 4, v27
    v_lshl_add_u32 v26, v26, 1, v133
    v_lshl_add_u32 v27, v27, 1, v133
    v_lshl_add_u32 v26, v134, 2, v26
    v_lshl_add_u32 v27, v135, 2, v27
    s_waitcnt vmcnt(12)
    ds_read_b64_tr_b16 a[64:65], v46 offset:8192
    ds_read_b64_tr_b16 a[66:67], v46 offset:8704
    ds_read_b64_tr_b16 a[68:69], v47 offset:8192
    ds_read_b64_tr_b16 a[70:71], v47 offset:8704
    s_waitcnt lgkmcnt(15)
    v_mfma_f32_16x16x32_f16 v[112:115], v[100:103], v[104:107], v[112:115]
    v_mfma_f32_16x16x32_f16 v[116:119], v[100:103], v[108:111], v[116:119]
    s_waitcnt lgkmcnt(7)
    buffer_load_dwordx4 v18, s[4:7], s22 offen offset:2048 lds
    ds_read_b128 v[100:103], v83 offset:40960
    ds_read_b128 v[104:107], v87 offset:40960
    ds_read_b128 v[108:111], v87 offset:45056
    buffer_load_dwordx4 v19, s[4:7], s22 offen offset:3072 lds
    s_add_u32 s22, s22, 114688
    s_cmp_eq_u32 s22, s82
    s_cselect_b32 s22, s83, s22
    v_cvt_pk_bf16_f32 v131, v128, v129
    v_pk_add_f32 v[128:129], v[128:129], v[130:131] op_sel_hi:[1,0]
    v_and_b32 v41, s59, v131
    v_lshlrev_b32 v40, 16, v131
    s_waitcnt vmcnt(12)
    ds_read_b64_tr_b16 a[72:73], v46 offset:10240
    ds_read_b64_tr_b16 a[74:75], v46 offset:10752
    ds_read_b64_tr_b16 a[76:77], v47 offset:10240
    ds_read_b64_tr_b16 a[78:79], v47 offset:10752
    v_cvt_u32_f32 v40, v40
    v_cvt_u32_f32 v41, v41
    v_lshrrev_b32 v134, 4, v40
    v_lshrrev_b32 v135, 4, v41
    s_waitcnt lgkmcnt(15)
    v_mfma_f32_16x16x32_f16 v[112:115], v[48:51], v[52:55], v[112:115]
    v_mfma_f32_16x16x32_f16 v[116:119], v[48:51], v[56:59], v[116:119]
    s_waitcnt lgkmcnt(7)
    s_add_u32 m0, s13, 8192
    s_nop 0
    buffer_load_dwordx4 v16, s[4:7], s22 offen offset:0 lds
    buffer_load_dwordx4 v17, s[4:7], s22 offen offset:1024 lds
    v_lshl_add_u32 v40, v40, 1, v133
    v_lshl_add_u32 v41, v41, 1, v133
    v_lshl_add_u32 v40, v134, 2, v40
    v_lshl_add_u32 v41, v135, 2, v41
    v_cvt_pk_bf16_f32 v131, v128, v129
    v_pk_add_f32 v[128:129], v[128:129], v[130:131] op_sel_hi:[1,0]
    v_and_b32 v43, s59, v131
    v_lshlrev_b32 v42, 16, v131
    s_waitcnt vmcnt(12)
    ds_read_b64_tr_b16 a[80:81], v46 offset:12288
    ds_read_b64_tr_b16 a[82:83], v46 offset:12800
    ds_read_b64_tr_b16 a[84:85], v47 offset:12288
    ds_read_b64_tr_b16 a[86:87], v47 offset:12800
    s_waitcnt lgkmcnt(15)
    v_mfma_f32_16x16x32_f16 v[112:115], v[60:63], v[64:67], v[112:115]
    v_mfma_f32_16x16x32_f16 v[116:119], v[60:63], v[68:71], v[116:119]
    s_waitcnt lgkmcnt(4)
    buffer_load_dwordx4 v18, s[4:7], s22 offen offset:2048 lds
    buffer_load_dwordx4 v19, s[4:7], s22 offen offset:3072 lds
    s_add_u32 s22, s22, 114688
    v_cvt_u32_f32 v42, v42
    v_cvt_u32_f32 v43, v43
    v_lshrrev_b32 v134, 4, v42
    v_lshrrev_b32 v135, 4, v43
    v_lshl_add_u32 v42, v42, 1, v133
    v_lshl_add_u32 v43, v43, 1, v133
    v_lshl_add_u32 v42, v134, 2, v42
    v_lshl_add_u32 v43, v135, 2, v43
    s_waitcnt vmcnt(12)
    ds_read_b64_tr_b16 a[88:89], v46 offset:14336
    ds_read_b64_tr_b16 a[90:91], v46 offset:14848
    ds_read_b64_tr_b16 a[92:93], v47 offset:14336
    ds_read_b64_tr_b16 a[94:95], v47 offset:14848
    s_waitcnt lgkmcnt(15)
    v_mfma_f32_16x16x32_f16 v[112:115], v[88:91], v[92:95], v[112:115]
    v_mfma_f32_16x16x32_f16 v[116:119], v[88:91], v[96:99], v[116:119]
    s_waitcnt lgkmcnt(4)
    s_add_u32 m0, s13, 12288
    s_nop 0
    buffer_load_dwordx4 v16, s[4:7], s22 offen offset:0 lds
    v_cvt_pk_bf16_f32 v131, v128, v129
    v_pk_add_f32 v[128:129], v[128:129], v[130:131] op_sel_hi:[1,0]
    v_and_b32 v137, s59, v131
    v_lshlrev_b32 v136, 16, v131
    buffer_load_dwordx4 v17, s[4:7], s22 offen offset:1024 lds
    v_cvt_u32_f32 v136, v136
    v_cvt_u32_f32 v137, v137
    v_lshrrev_b32 v134, 4, v136
    v_lshrrev_b32 v135, 4, v137
    s_waitcnt vmcnt(12)
    ds_read_b64_tr_b16 a[96:97], v46 offset:16384
    ds_read_b64_tr_b16 a[98:99], v46 offset:16896
    ds_read_b64_tr_b16 a[100:101], v47 offset:16384
    ds_read_b64_tr_b16 a[102:103], v47 offset:16896
    s_waitcnt lgkmcnt(15)
    v_mfma_f32_16x16x32_f16 v[112:115], v[100:103], v[104:107], v[112:115]
    v_mfma_f32_16x16x32_f16 v[116:119], v[100:103], v[108:111], v[116:119]
    s_waitcnt lgkmcnt(4)
    buffer_load_dwordx4 v18, s[4:7], s22 offen offset:2048 lds
    v_lshl_add_u32 v136, v136, 1, v133
    v_lshl_add_u32 v137, v137, 1, v133
    v_lshl_add_u32 v136, v134, 2, v136
    v_lshl_add_u32 v137, v135, 2, v137
    buffer_load_dwordx4 v19, s[4:7], s22 offen offset:3072 lds
    s_add_u32 s22, s22, 114688
    s_cmp_eq_u32 s22, s82
    s_cselect_b32 s22, s83, s22
    v_cvt_pk_bf16_f32 v131, v128, v129
    v_pk_add_f32 v[128:129], v[128:129], v[130:131] op_sel_hi:[1,0]
    v_and_b32 v139, s59, v131
    v_lshlrev_b32 v138, 16, v131
    s_waitcnt vmcnt(12)
    ds_read_b64_tr_b16 a[104:105], v46 offset:18432
    ds_read_b64_tr_b16 a[106:107], v46 offset:18944
    ds_read_b64_tr_b16 a[108:109], v47 offset:18432
    ds_read_b64_tr_b16 a[110:111], v47 offset:18944
    v_mov_b32 v120, s58
    v_mov_b32 v121, 0
    ds_write_b16 v120, v121 offset:1154
    v_cvt_u32_f32 v138, v138
    v_cvt_u32_f32 v139, v139
    v_lshrrev_b32 v134, 4, v138
    v_lshrrev_b32 v135, 4, v139
    s_waitcnt lgkmcnt(5)
    s_add_u32 m0, s13, 16384
    s_nop 0
    buffer_load_dwordx4 v16, s[4:7], s22 offen offset:0 lds
    v_lshl_add_u32 v138, v138, 1, v133
    v_lshl_add_u32 v139, v139, 1, v133
    v_lshl_add_u32 v138, v134, 2, v138
    v_lshl_add_u32 v139, v135, 2, v139
    v_pk_mul_f32 v[112:113], v[112:113], v[14:15] op_sel_hi:[1,0]
    v_pk_mul_f32 v[114:115], v[114:115], v[14:15] op_sel_hi:[1,0]
    v_pk_mul_f32 v[116:117], v[116:117], v[14:15] op_sel_hi:[1,0]
    v_pk_mul_f32 v[118:119], v[118:119], v[14:15] op_sel_hi:[1,0]
    buffer_load_dwordx4 v17, s[4:7], s22 offen offset:1024 lds
    v_cvt_pk_bf16_f32 v112, v112, v113
    v_cvt_pk_bf16_f32 v114, v114, v115
    v_cvt_pk_bf16_f32 v116, v116, v117
    v_cvt_pk_bf16_f32 v118, v118, v119
    s_waitcnt vmcnt(12)
    ds_read_b64_tr_b16 a[112:113], v46 offset:20480
    ds_read_b64_tr_b16 a[114:115], v46 offset:20992
    ds_read_b64_tr_b16 a[116:117], v47 offset:20480
    ds_read_b64_tr_b16 a[118:119], v47 offset:20992
    ds_write_b16 v12, v112 offset:0
    ds_write_b16_d16_hi v12, v112 offset:16
    ds_write_b16 v12, v114 offset:36
    ds_write_b16_d16_hi v12, v114 offset:52
    ds_write_b16 v13, v116 offset:0
    ds_write_b16_d16_hi v13, v116 offset:16
    ds_write_b16 v13, v118 offset:36
    ds_write_b16_d16_hi v13, v118 offset:52
    v_cvt_pk_bf16_f32 v131, v128, v129
    v_pk_add_f32 v[128:129], v[128:129], v[130:131] op_sel_hi:[1,0]
    v_and_b32 v141, s59, v131
    v_lshlrev_b32 v140, 16, v131
    s_waitcnt lgkmcnt(13)
    buffer_load_dwordx4 v18, s[4:7], s22 offen offset:2048 lds
    buffer_load_dwordx4 v19, s[4:7], s22 offen offset:3072 lds
    s_add_u32 s22, s22, 114688
    v_cvt_u32_f32 v140, v140
    v_cvt_u32_f32 v141, v141
    v_lshrrev_b32 v134, 4, v140
    v_lshrrev_b32 v135, 4, v141
    v_lshl_add_u32 v140, v140, 1, v133
    v_lshl_add_u32 v141, v141, 1, v133
    v_lshl_add_u32 v140, v134, 2, v140
    v_lshl_add_u32 v141, v135, 2, v141
    s_waitcnt vmcnt(12)
    ds_read_b64_tr_b16 a[120:121], v46 offset:22528
    ds_read_b64_tr_b16 a[122:123], v46 offset:23040
    ds_read_b64_tr_b16 a[124:125], v47 offset:22528
    ds_read_b64_tr_b16 a[126:127], v47 offset:23040
    v_cvt_pk_bf16_f32 v131, v128, v129
    v_pk_add_f32 v[128:129], v[128:129], v[130:131] op_sel_hi:[1,0]
    v_and_b32 v143, s59, v131
    v_lshlrev_b32 v142, 16, v131
    s_waitcnt lgkmcnt(12)
    s_add_u32 m0, s13, 20480
    s_nop 0
    buffer_load_dwordx4 v16, s[4:7], s22 offen offset:0 lds
    v_cvt_u32_f32 v142, v142
    v_cvt_u32_f32 v143, v143
    v_lshrrev_b32 v134, 4, v142
    v_lshrrev_b32 v135, 4, v143
    v_lshl_add_u32 v142, v142, 1, v133
    v_lshl_add_u32 v143, v143, 1, v133
    v_lshl_add_u32 v142, v134, 2, v142
    v_lshl_add_u32 v143, v135, 2, v143
    buffer_load_dwordx4 v17, s[4:7], s22 offen offset:1024 lds
    v_cvt_pk_bf16_f32 v131, v128, v129
    v_pk_add_f32 v[128:129], v[128:129], v[130:131] op_sel_hi:[1,0]
    v_and_b32 v145, s59, v131
    v_lshlrev_b32 v144, 16, v131
    s_waitcnt vmcnt(12)
    ds_read_b64_tr_b16 a[128:129], v46 offset:8192
    ds_read_b64_tr_b16 a[130:131], v46 offset:8704
    ds_read_b64_tr_b16 a[132:133], v47 offset:8192
    ds_read_b64_tr_b16 a[134:135], v47 offset:8704
    v_cvt_u32_f32 v144, v144
    v_cvt_u32_f32 v145, v145
    v_lshrrev_b32 v134, 4, v144
    v_lshrrev_b32 v135, 4, v145
    v_lshl_add_u32 v144, v144, 1, v133
    v_lshl_add_u32 v145, v145, 1, v133
    v_lshl_add_u32 v144, v134, 2, v144
    v_lshl_add_u32 v145, v135, 2, v145
    s_waitcnt lgkmcnt(4)
    buffer_load_dwordx4 v18, s[4:7], s22 offen offset:2048 lds
    v_cvt_pk_bf16_f32 v131, v128, v129
    v_pk_add_f32 v[128:129], v[128:129], v[130:131] op_sel_hi:[1,0]
    v_and_b32 v147, s59, v131
    v_lshlrev_b32 v146, 16, v131
    v_cmp_gt_f32 s[28:29], 0, v146
    v_cmp_gt_f32 s[26:27], 0, v147
    s_nop 0
    v_cndmask_b32 v146, v146, v132, s[28:29]
    v_cndmask_b32 v147, v147, v132, s[26:27]
    buffer_load_dwordx4 v19, s[4:7], s22 offen offset:3072 lds
    s_add_u32 s22, s22, 114688
    s_cmp_eq_u32 s22, s82
    s_cselect_b32 s22, s83, s22
    v_cvt_u32_f32 v146, v146
    v_cvt_u32_f32 v147, v147
    v_lshrrev_b32 v134, 4, v146
    v_lshrrev_b32 v135, 4, v147
    s_waitcnt vmcnt(12)
    ds_read_b64_tr_b16 a[136:137], v46 offset:10240
    ds_read_b64_tr_b16 a[138:139], v46 offset:10752
    ds_read_b64_tr_b16 a[140:141], v47 offset:10240
    ds_read_b64_tr_b16 a[142:143], v47 offset:10752
    v_lshl_add_u32 v146, v146, 1, v133
    v_lshl_add_u32 v147, v147, 1, v133
    v_lshl_add_u32 v146, v134, 2, v146
    v_lshl_add_u32 v147, v135, 2, v147
    s_waitcnt lgkmcnt(4)
    s_add_u32 m0, s13, 8192
    s_nop 0
    buffer_load_dwordx4 v16, s[4:7], s22 offen offset:0 lds
    v_cvt_pk_bf16_f32 v131, v128, v129
    v_and_b32 v149, s59, v131
    v_lshlrev_b32 v148, 16, v131
    v_cmp_gt_f32 s[28:29], 0, v148
    v_cmp_gt_f32 s[26:27], 0, v149
    s_nop 0
    v_cndmask_b32 v148, v148, v132, s[28:29]
    v_cndmask_b32 v149, v149, v132, s[26:27]
    buffer_load_dwordx4 v17, s[4:7], s22 offen offset:1024 lds
    v_cvt_u32_f32 v148, v148
    v_lshrrev_b32 v134, 4, v148
    v_lshl_add_u32 v148, v148, 1, v133
    v_lshl_add_u32 v148, v134, 2, v148
    s_waitcnt vmcnt(12)
    ds_read_b64_tr_b16 a[144:145], v46 offset:12288
    ds_read_b64_tr_b16 a[146:147], v46 offset:12800
    ds_read_b64_tr_b16 a[148:149], v47 offset:12288
    ds_read_b64_tr_b16 a[150:151], v47 offset:12800
    s_lshl_b32 s27, s20, 6
    s_add_u32 s27, s27, s13
    s_add_u32 s27, s27, 30720
    v_lshl_add_u32 v150, v1, 2, s27
    s_mul_i32 s27, s19, 81920
    s_add_u32 s27, s27, 26624
    v_add_u32 v36, s27, v36
    s_waitcnt lgkmcnt(15)
    s_barrier
    ds_read_u16 v26, v26
    ds_read_u16 v27, v27
    ds_read_u16 v40, v40
    ds_read_u16 v41, v41
    s_waitcnt lgkmcnt(8)
    buffer_load_dwordx4 v18, s[4:7], s22 offen offset:2048 lds
    buffer_load_dwordx4 v19, s[4:7], s22 offen offset:3072 lds
    s_add_u32 s22, s22, 114688
    ds_read_u16 v42, v42
    ds_read_u16 v43, v43
    ds_read_u16 v136, v136
    ds_read_u16 v137, v137
    ds_read_u16 v138, v138
    ds_read_u16 v139, v139
    ds_read_u16 v140, v140
    ds_read_u16 v141, v141
    s_waitcnt vmcnt(12)
    ds_read_b64_tr_b16 a[152:153], v46 offset:14336
    ds_read_b64_tr_b16 a[154:155], v46 offset:14848
    ds_read_b64_tr_b16 a[156:157], v47 offset:14336
    ds_read_b64_tr_b16 a[158:159], v47 offset:14848
    ds_read_u16 v142, v142
    ds_read_u16 v143, v143
    ds_read_u16 v144, v144
    ds_read_u16 v145, v145
    global_load_dwordx2 v[12:13], v8, s[80:81] sc1
    s_waitcnt lgkmcnt(15)
    s_add_u32 m0, s13, 12288
    s_nop 0
    buffer_load_dwordx4 v16, s[4:7], s22 offen offset:0 lds
    ds_read_u16 v146, v146
    ds_read_u16 v147, v147
    ds_read_u16 v148, v148
    ds_write_b32 v150, v121
    ds_write_b32 v150, v121 offset:4384
    buffer_load_dwordx4 v17, s[4:7], s22 offen offset:1024 lds
    s_waitcnt lgkmcnt(2)
    v_lshl_or_b32 v112, v27, 16, v26
    v_lshl_or_b32 v113, v41, 16, v40
    v_lshl_or_b32 v114, v43, 16, v42
    v_lshl_or_b32 v115, v137, 16, v136
    v_lshl_or_b32 v116, v139, 16, v138
    v_lshl_or_b32 v117, v141, 16, v140
    v_lshl_or_b32 v118, v143, 16, v142
    v_lshl_or_b32 v119, v145, 16, v144
    ds_write_b128 v36, v[112:115] offset:0
    ds_write_b128 v36, v[116:119] offset:16
    s_waitcnt vmcnt(13)
    ds_read_b64_tr_b16 a[160:161], v46 offset:16384
    ds_read_b64_tr_b16 a[162:163], v46 offset:16896
    ds_read_b64_tr_b16 a[164:165], v47 offset:16384
    ds_read_b64_tr_b16 a[166:167], v47 offset:16896
    v_lshl_or_b32 v120, v40, 16, v27
    v_lshl_or_b32 v121, v42, 16, v41
    v_lshl_or_b32 v122, v136, 16, v43
    v_lshl_or_b32 v123, v138, 16, v137
    s_waitcnt lgkmcnt(15)
    buffer_load_dwordx4 v18, s[4:7], s22 offen offset:2048 lds
    v_lshl_or_b32 v124, v140, 16, v139
    v_lshl_or_b32 v125, v142, 16, v141
    v_lshl_or_b32 v126, v144, 16, v143
    v_lshl_or_b32 v127, v146, 16, v145
    ds_write_b128 v36, v[120:123] offset:4384
    ds_write_b128 v36, v[124:127] offset:4400
    buffer_load_dwordx4 v19, s[4:7], s22 offen offset:3072 lds
    s_add_u32 s22, s22, 114688
    s_cmp_eq_u32 s22, s82
    s_cselect_b32 s22, s83, s22
    v_lshl_or_b32 v112, v41, 16, v40
    v_lshl_or_b32 v113, v43, 16, v42
    v_lshl_or_b32 v114, v137, 16, v136
    v_lshl_or_b32 v115, v139, 16, v138
    s_waitcnt vmcnt(13)
    ds_read_b64_tr_b16 a[168:169], v46 offset:18432
    ds_read_b64_tr_b16 a[170:171], v46 offset:18944
    ds_read_b64_tr_b16 a[172:173], v47 offset:18432
    ds_read_b64_tr_b16 a[174:175], v47 offset:18944
    v_lshl_or_b32 v116, v141, 16, v140
    v_lshl_or_b32 v117, v143, 16, v142
    v_lshl_or_b32 v118, v145, 16, v144
    v_lshl_or_b32 v119, v147, 16, v146
    ds_write_b128 v36, v[112:115] offset:41024
    ds_write_b128 v36, v[116:119] offset:41040
    global_load_dwordx2 v[14:15], v8, s[80:81] sc1
    s_waitcnt lgkmcnt(8)
    s_add_u32 m0, s13, 16384
    s_nop 0
    buffer_load_dwordx4 v16, s[4:7], s22 offen offset:0 lds
    v_lshl_or_b32 v120, v42, 16, v41
    v_lshl_or_b32 v121, v136, 16, v43
    v_lshl_or_b32 v122, v138, 16, v137
    v_lshl_or_b32 v123, v140, 16, v139
    v_lshl_or_b32 v124, v142, 16, v141
    v_lshl_or_b32 v125, v144, 16, v143
    v_lshl_or_b32 v126, v146, 16, v145
    v_lshl_or_b32 v127, v148, 16, v147
    ds_write_b128 v36, v[120:123] offset:45408
    ds_write_b128 v36, v[124:127] offset:45424
    buffer_load_dwordx4 v17, s[4:7], s22 offen offset:1024 lds
    s_waitcnt vmcnt(14)
    ds_read_b64_tr_b16 a[176:177], v46 offset:20480
    ds_read_b64_tr_b16 a[178:179], v46 offset:20992
    ds_read_b64_tr_b16 a[180:181], v47 offset:20480
    ds_read_b64_tr_b16 a[182:183], v47 offset:20992
    s_waitcnt lgkmcnt(8)
    buffer_load_dwordx4 v18, s[4:7], s22 offen offset:2048 lds
    buffer_load_dwordx4 v19, s[4:7], s22 offen offset:3072 lds
    s_add_u32 s22, s22, 114688
    s_waitcnt vmcnt(14)
    ds_read_b64_tr_b16 a[184:185], v46 offset:22528
    ds_read_b64_tr_b16 a[186:187], v46 offset:23040
    ds_read_b64_tr_b16 a[188:189], v47 offset:22528
    ds_read_b64_tr_b16 a[190:191], v47 offset:23040
    global_load_dwordx2 v[26:27], v8, s[80:81] sc1
    s_waitcnt lgkmcnt(4)
    s_add_u32 m0, s13, 20480
    s_nop 0
    buffer_load_dwordx4 v16, s[4:7], s22 offen offset:0 lds
    buffer_load_dwordx4 v17, s[4:7], s22 offen offset:1024 lds
    s_waitcnt vmcnt(15)
    ds_read_b64_tr_b16 a[192:193], v46 offset:8192
    ds_read_b64_tr_b16 a[194:195], v46 offset:8704
    ds_read_b64_tr_b16 a[196:197], v47 offset:8192
    ds_read_b64_tr_b16 a[198:199], v47 offset:8704
    s_waitcnt lgkmcnt(4)
    buffer_load_dwordx4 v18, s[4:7], s22 offen offset:2048 lds
    buffer_load_dwordx4 v19, s[4:7], s22 offen offset:3072 lds
    s_waitcnt vmcnt(15)
    ds_read_b64_tr_b16 a[200:201], v46 offset:10240
    ds_read_b64_tr_b16 a[202:203], v46 offset:10752
    ds_read_b64_tr_b16 a[204:205], v47 offset:10240
    ds_read_b64_tr_b16 a[206:207], v47 offset:10752
    s_waitcnt vmcnt(14)
    v_subrev_u32 v12, s100, v12
    v_cmp_ne_u32 s[26:27], s101, v13
    v_subrev_u32 v12, 1, v12
    v_cmp_lt_u32 vcc, 2, v12
    s_nop 1
    s_or_b64 s[26:27], s[26:27], vcc
    s_cbranch_scc0 L_poll2_ok
    s_waitcnt vmcnt(9)
    v_subrev_u32 v14, s100, v14
    v_cmp_ne_u32 s[26:27], s101, v15
    v_subrev_u32 v14, 1, v14
    v_cmp_lt_u32 vcc, 2, v14
    s_nop 1
    s_or_b64 s[26:27], s[26:27], vcc
    s_cbranch_scc0 L_poll2_ok
    s_waitcnt vmcnt(4)
    v_subrev_u32 v26, s100, v26
    v_cmp_ne_u32 s[26:27], s101, v27
    v_subrev_u32 v26, 1, v26
    v_cmp_lt_u32 vcc, 2, v26
    s_nop 1
    s_or_b64 s[26:27], s[26:27], vcc
    s_cbranch_scc0 L_poll2_ok
    s_mov_b32 s28, 0
L_poll2:
    global_load_dwordx2 v[24:25], v8, s[80:81] sc1
    s_add_u32 s28, s28, 1
    s_cmp_ge_u32 s28, 0x8000
    s_cbranch_scc1 L_poll2_ok
    s_waitcnt vmcnt(0)
    v_subrev_u32 v24, s100, v24
    v_cmp_ne_u32 s[26:27], s101, v25
    v_subrev_u32 v24, 1, v24
    v_cmp_lt_u32 vcc, 2, v24
    s_nop 1
    s_or_b64 s[26:27], s[26:27], vcc
    s_cbranch_scc1 L_poll2
L_poll2_ok:
    s_lshl_b32 s23, s16, 18
    s_lshl_b32 s26, s12, 16
    s_add_u32 s23, s23, s26
    s_mov_b32 s93, s23
    s_add_u32 s92, s23, 65536
    s_lshl_b32 s26, s94, 13
    s_add_u32 s23, s23, s26
    s_mov_b32 s91, s23
    v_mov_b32 v8, v2
    s_mov_b32 s52, s8
    s_mov_b32 s53, s9
    s_mov_b32 s54, s10
    s_mov_b32 s55, s11
    buffer_load_dwordx4 v[252:255], v8, s[52:55], s23 offen offset:0
    buffer_load_dwordx4 v[248:251], v8, s[52:55], s23 offen offset:2048
    s_add_u32 s23, s23, 4096
    buffer_load_dwordx4 v[244:247], v8, s[52:55], s23 offen offset:0
    buffer_load_dwordx4 v[240:243], v8, s[52:55], s23 offen offset:2048
    s_add_u32 s23, s23, 4096
    s_cmp_eq_u32 s23, s92
    s_cselect_b32 s23, s93, s23
    buffer_load_dwordx4 v[236:239], v8, s[52:55], s23 offen offset:0
    buffer_load_dwordx4 v[232:235], v8, s[52:55], s23 offen offset:2048
    s_add_u32 s23, s23, 4096
    buffer_load_dwordx4 v[228:231], v8, s[52:55], s23 offen offset:0
    buffer_load_dwordx4 v[224:227], v8, s[52:55], s23 offen offset:2048
    s_add_u32 s23, s23, 4096
    s_cmp_eq_u32 s23, s92
    s_cselect_b32 s23, s93, s23
    buffer_load_dwordx4 v[12:15], v8, s[52:55], s23 offen offset:0
    buffer_load_dwordx4 v[40:43], v8, s[52:55], s23 offen offset:2048
    s_add_u32 s23, s23, 4096
    buffer_load_dwordx4 v[48:51], v8, s[52:55], s23 offen offset:0
    buffer_load_dwordx4 v[52:55], v8, s[52:55], s23 offen offset:2048
    s_add_u32 s23, s23, 4096
    s_cmp_eq_u32 s23, s92
    s_cselect_b32 s23, s93, s23
    buffer_load_dwordx4 v[56:59], v8, s[52:55], s23 offen offset:0
    buffer_load_dwordx4 v[60:63], v8, s[52:55], s23 offen offset:2048
    s_add_u32 s23, s23, 4096
    buffer_load_dwordx4 v[64:67], v8, s[52:55], s23 offen offset:0
    buffer_load_dwordx4 v[68:71], v8, s[52:55], s23 offen offset:2048
    s_add_u32 s23, s23, 4096
    s_cmp_eq_u32 s23, s92
    s_cselect_b32 s23, s93, s23
    buffer_load_dwordx4 v[80:83], v8, s[52:55], s23 offen offset:0
    buffer_load_dwordx4 v[84:87], v8, s[52:55], s23 offen offset:2048
    s_add_u32 s23, s23, 4096
    s_waitcnt vmcnt(17) lgkmcnt(15)
    v_mfma_f32_32x32x16_bf16 v[192:207], a[0:3], v[252:255], 0
    buffer_load_dwordx4 v[88:91], v8, s[52:55], s23 offen offset:0
    s_waitcnt vmcnt(31)
    ds_read_b64_tr_b16 a[208:209], v46 offset:12288
    ds_read_b64_tr_b16 a[210:211], v46 offset:12800
    ds_read_b64_tr_b16 a[212:213], v47 offset:12288
    ds_read_b64_tr_b16 a[214:215], v47 offset:12800
    s_waitcnt vmcnt(29)
    ds_read_b64_tr_b16 a[216:217], v46 offset:14336
    ds_read_b64_tr_b16 a[218:219], v46 offset:14848
    ds_read_b64_tr_b16 a[220:221], v47 offset:14336
    ds_read_b64_tr_b16 a[222:223], v47 offset:14848
    v_mfma_f32_32x32x16_bf16 v[208:223], a[4:7], v[252:255], 0
    buffer_load_dwordx4 v[252:255], v8, s[52:55], s23 offen offset:2048
    s_add_u32 s23, s23, 4096
    s_cmp_eq_u32 s23, s92
    s_cselect_b32 s23, s93, s23
    s_waitcnt vmcnt(27)
    ds_read_b64_tr_b16 a[224:225], v46 offset:16384
    ds_read_b64_tr_b16 a[226:227], v46 offset:16896
    ds_read_b64_tr_b16 a[228:229], v47 offset:16384
    ds_read_b64_tr_b16 a[230:231], v47 offset:16896
    s_waitcnt vmcnt(18) lgkmcnt(15)
    v_mfma_f32_32x32x16_bf16 v[192:207], a[8:11], v[248:251], v[192:207]
    buffer_load_dwordx4 v[92:95], v8, s[52:55], s23 offen offset:0
    s_waitcnt vmcnt(26)
    ds_read_b64_tr_b16 a[232:233], v46 offset:18432
    ds_read_b64_tr_b16 a[234:235], v46 offset:18944
    ds_read_b64_tr_b16 a[236:237], v47 offset:18432
    ds_read_b64_tr_b16 a[238:239], v47 offset:18944
    v_mfma_f32_32x32x16_bf16 v[208:223], a[12:15], v[248:251], v[208:223]
    buffer_load_dwordx4 v[248:251], v8, s[52:55], s23 offen offset:2048
    s_add_u32 s23, s23, 4096
    s_waitcnt vmcnt(24)
    ds_read_b64_tr_b16 a[240:241], v46 offset:20480
    ds_read_b64_tr_b16 a[242:243], v46 offset:20992
    ds_read_b64_tr_b16 a[244:245], v47 offset:20480
    ds_read_b64_tr_b16 a[246:247], v47 offset:20992
    s_waitcnt vmcnt(22)
    ds_read_b64_tr_b16 a[248:249], v46 offset:22528
    ds_read_b64_tr_b16 a[250:251], v46 offset:23040
    ds_read_b64_tr_b16 a[252:253], v47 offset:22528
    ds_read_b64_tr_b16 a[254:255], v47 offset:23040
    s_waitcnt vmcnt(19) lgkmcnt(15)
    v_mfma_f32_32x32x16_bf16 v[192:207], a[16:19], v[244:247], v[192:207]
    buffer_load_dwordx4 v[96:99], v8, s[52:55], s23 offen offset:0
    v_and_b32 v100, 15, v1
    v_lshrrev_b32 v101, 5, v1
    v_bfe_u32 v102, v1, 4, 1
    v_sub_u32 v26, v100, v101
    v_mfma_f32_32x32x16_bf16 v[208:223], a[20:23], v[244:247], v[208:223]
    buffer_load_dwordx4 v[244:247], v8, s[52:55], s23 offen offset:2048
    s_add_u32 s23, s23, 4096
    s_cmp_eq_u32 s23, s92
    s_cselect_b32 s23, s93, s23
    v_lshlrev_b32 v26, 5, v26
    v_lshl_add_u32 v26, v102, 4, v26
    v_lshlrev_b32 v27, 4, v102
    v_lshlrev_b32 v103, 5, v101
    s_waitcnt vmcnt(20) lgkmcnt(15)
    v_mfma_f32_32x32x16_bf16 v[192:207], a[24:27], v[240:243], v[192:207]
    buffer_load_dwordx4 v[104:107], v8, s[52:55], s23 offen offset:0
    v_sub_u32 v27, v27, v103
    v_lshlrev_b32 v103, 1, v100
    v_sub_u32 v27, v27, v103
    v_sub_u32 v103, 3, v100
    v_and_b32 v101, 1, v103
    v_mul_u32_u24 v101, 4382, v101
    v_add_u32 v27, v27, v101
    v_bfe_u32 v101, v103, 1, 1
    v_mfma_f32_32x32x16_bf16 v[208:223], a[28:31], v[240:243], v[208:223]
    buffer_load_dwordx4 v[240:243], v8, s[52:55], s23 offen offset:2048
    s_add_u32 s23, s23, 4096
    v_mul_u32_u24 v101, 41020, v101
    v_add_u32 v27, v27, v101
    s_mul_i32 s27, s19, 81920
    s_lshl_b32 s28, s20, 7
    s_sub_u32 s27, s27, s28
    s_add_u32 s26, s27, 76608
    v_add_u32 v26, s26, v26
    s_add_u32 s26, s27, 26814
    v_add_u32 v27, s26, v27
    v_add_u32 v36, 2048, v27
    s_waitcnt vmcnt(21) lgkmcnt(15)
    v_mfma_f32_32x32x16_bf16 v[192:207], a[32:35], v[236:239], v[192:207]
    buffer_load_dwordx4 v[108:111], v8, s[52:55], s23 offen offset:0
    s_add_u32 s26, s13, 18432
    v_lshl_add_u32 v112, v1, 4, s26
    s_xor_b32 s27, s12, 1
    s_mul_i32 s27, s27, 40960
    s_add_u32 s27, s27, 18432
    v_lshl_add_u32 v113, v1, 4, s27
    v_mfma_f32_32x32x16_bf16 v[208:223], a[36:39], v[236:239], v[208:223]
    buffer_load_dwordx4 v[236:239], v8, s[52:55], s23 offen offset:2048
    s_add_u32 s23, s23, 4096
    s_cmp_eq_u32 s23, s92
    s_cselect_b32 s23, s93, s23
    v_lshrrev_b32 v101, 4, v1
    v_lshlrev_b32 v102, 5, v100
    v_lshl_add_u32 v102, v101, 3, v102
    s_waitcnt vmcnt(22) lgkmcnt(15)
    v_mfma_f32_32x32x16_bf16 v[192:207], a[40:43], v[232:235], v[192:207]
    buffer_load_dwordx4 v[116:119], v8, s[52:55], s23 offen offset:0
    s_mul_i32 s27, s19, 81920
    s_lshl_b32 s28, s20, 11
    s_add_u32 s27, s27, s28
    s_add_u32 s27, s27, 76928
    v_add_u32 v114, s27, v102
    s_lshl_b32 s27, s21, 12
    s_add_u32 s27, s27, s28
    s_add_u32 s27, s27, 8388608
    v_add_u32 v115, s27, v102
    v_mfma_f32_32x32x16_bf16 v[208:223], a[44:47], v[232:235], v[208:223]
    buffer_load_dwordx4 v[232:235], v8, s[52:55], s23 offen offset:2048
    s_add_u32 s23, s23, 4096
    v_lshlrev_b32 v101, 8, v101
    v_lshl_add_u32 v101, v100, 3, v101
    s_add_u32 s27, s13, 26624
    v_add_u32 v120, s27, v101
    s_waitcnt vmcnt(23) lgkmcnt(15)
    v_mfma_f32_32x32x16_bf16 v[192:207], a[48:51], v[228:231], v[192:207]
    buffer_load_dwordx4 v[124:127], v8, s[52:55], s23 offen offset:0
    v_lshrrev_b32 v100, 1, v1
    v_lshlrev_b32 v100, 12, v100
    v_and_b32 v101, 1, v1
    v_lshl_add_u32 v121, v101, 4, v100
    s_lshl_b32 s30, s31, 1
    s_lshl_b32 s27, s18, 18
    s_add_u32 s30, s30, s27
    s_add_u32 s30, s30, 8388608
    v_mfma_f32_32x32x16_bf16 v[208:223], a[52:55], v[228:231], v[208:223]
    buffer_load_dwordx4 v[228:231], v8, s[52:55], s23 offen offset:2048
    v_min_u32 v100, 6, v1
    s_lshl_b32 s26, s18, 5
    s_mul_i32 s27, s12, 7
    s_add_u32 s27, s27, s26
    s_lshl_b32 s27, s27, 3
    s_add_u32 s27, s27, 12648448
    v_lshl_add_u32 v122, v100, 3, s27
    s_waitcnt vmcnt(24) lgkmcnt(15)
    v_mfma_f32_32x32x16_bf16 v[192:207], a[56:59], v[224:227], v[192:207]
    buffer_load_dwordx4 v[128:131], v8, s[52:55], s91 offen offset:512
    v_and_b32 v100, 31, v1
    s_lshl_b32 s26, s18, 8
    s_add_u32 s26, s26, 12582912
    v_lshl_add_u32 v123, v100, 3, s26
    v_and_b32 v136, 31, v1
    v_lshrrev_b32 v137, 5, v1
    v_xor_b32 v137, v137, v136
    v_and_b32 v137, 7, v137
    v_lshlrev_b32 v136, 7, v136
    v_lshl_add_u32 v136, v137, 4, v136
    s_add_u32 s26, s13, 18432
    v_add_u32 v100, s26, v136
    v_xor_b32 v101, 32, v100
    v_xor_b32 v102, 64, v100
    v_xor_b32 v103, 96, v100
    v_lshrrev_b32 v136, 4, v1
    v_lshlrev_b32 v136, 1, v136
    v_and_b32 v137, 7, v1
    v_xor_b32 v136, v136, v137
    v_and_b32 v137, 15, v1
    v_lshlrev_b32 v137, 7, v137
    v_lshl_add_u32 v136, v136, 4, v137
    s_lshl_b32 s26, s12, 11
    s_add_u32 s26, s26, 18432
    v_add_u32 v132, s26, v136
    v_xor_b32 v133, 16, v132
    v_add_u32 v134, 81920, v132
    v_add_u32 v135, 81920, v133
    v_mfma_f32_32x32x16_bf16 v[208:223], a[60:63], v[224:227], v[208:223]
    s_waitcnt vmcnt(24) lgkmcnt(15)
    v_mfma_f32_32x32x16_bf16 v[192:207], a[64:67], v[12:15], v[192:207]
    v_mfma_f32_32x32x16_bf16 v[208:223], a[68:71], v[12:15], v[208:223]
    buffer_load_dwordx4 v[12:15], v8, s[52:55], s91 offen offset:2560
    s_add_u32 s91, s91, 4096
    v_lshlrev_b32 v44, 16, v44
    v_lshlrev_b32 v38, 16, v38
    v_mov_b32 v45, v44
    v_mov_b32 v39, v38
    s_waitcnt vmcnt(24) lgkmcnt(15)
    v_mfma_f32_32x32x16_bf16 v[192:207], a[72:75], v[40:43], v[192:207]
    v_mfma_f32_32x32x16_bf16 v[208:223], a[76:79], v[40:43], v[208:223]
    buffer_load_dwordx4 v[40:43], v8, s[52:55], s91 offen offset:512
    s_waitcnt vmcnt(24) lgkmcnt(15)
    v_mfma_f32_32x32x16_bf16 v[192:207], a[80:83], v[48:51], v[192:207]
    v_mfma_f32_32x32x16_bf16 v[208:223], a[84:87], v[48:51], v[208:223]
    buffer_load_dwordx4 v[48:51], v8, s[52:55], s91 offen offset:2560
    s_add_u32 s91, s91, 4096
    s_cmp_eq_u32 s91, s92
    s_cselect_b32 s91, s93, s91
    s_waitcnt vmcnt(24) lgkmcnt(15)
    v_mfma_f32_32x32x16_bf16 v[192:207], a[88:91], v[52:55], v[192:207]
    v_mfma_f32_32x32x16_bf16 v[208:223], a[92:95], v[52:55], v[208:223]
    buffer_load_dwordx4 v[52:55], v8, s[52:55], s91 offen offset:512
    s_waitcnt vmcnt(24) lgkmcnt(15)
    v_mfma_f32_32x32x16_bf16 v[192:207], a[96:99], v[56:59], v[192:207]
    v_mfma_f32_32x32x16_bf16 v[208:223], a[100:103], v[56:59], v[208:223]
    buffer_load_dwordx4 v[56:59], v8, s[52:55], s91 offen offset:2560
    s_add_u32 s91, s91, 4096
    s_waitcnt vmcnt(24) lgkmcnt(15)
    v_mfma_f32_32x32x16_bf16 v[192:207], a[104:107], v[60:63], v[192:207]
    v_mfma_f32_32x32x16_bf16 v[208:223], a[108:111], v[60:63], v[208:223]
    buffer_load_dwordx4 v[60:63], v8, s[52:55], s91 offen offset:512
    s_waitcnt vmcnt(24) lgkmcnt(15)
    v_mfma_f32_32x32x16_bf16 v[192:207], a[112:115], v[64:67], v[192:207]
    v_mfma_f32_32x32x16_bf16 v[208:223], a[116:119], v[64:67], v[208:223]
    buffer_load_dwordx4 v[64:67], v8, s[52:55], s91 offen offset:2560
    s_add_u32 s91, s91, 4096
    s_cmp_eq_u32 s91, s92
    s_cselect_b32 s91, s93, s91
    s_waitcnt vmcnt(24) lgkmcnt(15)
    v_mfma_f32_32x32x16_bf16 v[192:207], a[120:123], v[68:71], v[192:207]
    v_mfma_f32_32x32x16_bf16 v[208:223], a[124:127], v[68:71], v[208:223]
    buffer_load_dwordx4 v[68:71], v8, s[52:55], s91 offen offset:512
    s_waitcnt vmcnt(24) lgkmcnt(15)
    v_mfma_f32_32x32x16_bf16 v[192:207], a[128:131], v[80:83], v[192:207]
    v_mfma_f32_32x32x16_bf16 v[208:223], a[132:135], v[80:83], v[208:223]
    buffer_load_dwordx4 v[80:83], v8, s[52:55], s91 offen offset:2560
    s_add_u32 s91, s91, 4096
    s_waitcnt vmcnt(24) lgkmcnt(15)
    v_mfma_f32_32x32x16_bf16 v[192:207], a[136:139], v[84:87], v[192:207]
    v_mfma_f32_32x32x16_bf16 v[208:223], a[140:143], v[84:87], v[208:223]
    buffer_load_dwordx4 v[84:87], v8, s[52:55], s91 offen offset:512
    s_waitcnt vmcnt(24) lgkmcnt(15)
    v_mfma_f32_32x32x16_bf16 v[192:207], a[144:147], v[88:91], v[192:207]
    v_mfma_f32_32x32x16_bf16 v[208:223], a[148:151], v[88:91], v[208:223]
    buffer_load_dwordx4 v[88:91], v8, s[52:55], s91 offen offset:2560
    s_add_u32 s91, s91, 4096
    s_cmp_eq_u32 s91, s92
    s_cselect_b32 s91, s93, s91
    s_waitcnt vmcnt(24) lgkmcnt(15)
    v_mfma_f32_32x32x16_bf16 v[192:207], a[152:155], v[252:255], v[192:207]
    v_mfma_f32_32x32x16_bf16 v[208:223], a[156:159], v[252:255], v[208:223]
    s_waitcnt vmcnt(23) lgkmcnt(15)
    v_mfma_f32_32x32x16_bf16 v[192:207], a[160:163], v[92:95], v[192:207]
    v_mfma_f32_32x32x16_bf16 v[208:223], a[164:167], v[92:95], v[208:223]
    buffer_load_dwordx4 v[92:95], v8, s[52:55], s91 offen offset:512
    s_waitcnt vmcnt(23) lgkmcnt(15)
    v_mfma_f32_32x32x16_bf16 v[192:207], a[168:171], v[248:251], v[192:207]
    v_mfma_f32_32x32x16_bf16 v[208:223], a[172:175], v[248:251], v[208:223]
    s_waitcnt vmcnt(22) lgkmcnt(15)
    v_mfma_f32_32x32x16_bf16 v[192:207], a[176:179], v[96:99], v[192:207]
    v_mfma_f32_32x32x16_bf16 v[208:223], a[180:183], v[96:99], v[208:223]
    buffer_load_dwordx4 v[96:99], v8, s[52:55], s91 offen offset:2560
    s_add_u32 s91, s91, 4096
    s_waitcnt vmcnt(22) lgkmcnt(15)
    v_mfma_f32_32x32x16_bf16 v[192:207], a[184:187], v[244:247], v[192:207]
    v_mfma_f32_32x32x16_bf16 v[208:223], a[188:191], v[244:247], v[208:223]
    s_waitcnt vmcnt(21) lgkmcnt(15)
    v_mfma_f32_32x32x16_bf16 v[192:207], a[192:195], v[104:107], v[192:207]
    v_mfma_f32_32x32x16_bf16 v[208:223], a[196:199], v[104:107], v[208:223]
    buffer_load_dwordx4 v[104:107], v8, s[52:55], s91 offen offset:512
    s_waitcnt vmcnt(21) lgkmcnt(15)
    v_mfma_f32_32x32x16_bf16 v[192:207], a[200:203], v[240:243], v[192:207]
    v_mfma_f32_32x32x16_bf16 v[208:223], a[204:207], v[240:243], v[208:223]
    s_waitcnt vmcnt(20) lgkmcnt(15)
    v_mfma_f32_32x32x16_bf16 v[192:207], a[208:211], v[108:111], v[192:207]
    v_mfma_f32_32x32x16_bf16 v[208:223], a[212:215], v[108:111], v[208:223]
    buffer_load_dwordx4 v[108:111], v8, s[52:55], s91 offen offset:2560
    s_add_u32 s91, s91, 4096
    s_cmp_eq_u32 s91, s92
    s_cselect_b32 s91, s93, s91
    s_waitcnt vmcnt(20) lgkmcnt(15)
    v_mfma_f32_32x32x16_bf16 v[192:207], a[216:219], v[236:239], v[192:207]
    v_mfma_f32_32x32x16_bf16 v[208:223], a[220:223], v[236:239], v[208:223]
    s_waitcnt vmcnt(19) lgkmcnt(12)
    v_mfma_f32_32x32x16_bf16 v[192:207], a[224:227], v[116:119], v[192:207]
    v_mfma_f32_32x32x16_bf16 v[208:223], a[228:231], v[116:119], v[208:223]
    buffer_load_dwordx4 v[116:119], v8, s[52:55], s91 offen offset:512
    s_waitcnt vmcnt(19) lgkmcnt(8)
    v_mfma_f32_32x32x16_bf16 v[192:207], a[232:235], v[232:235], v[192:207]
    v_mfma_f32_32x32x16_bf16 v[208:223], a[236:239], v[232:235], v[208:223]
    s_waitcnt vmcnt(18) lgkmcnt(4)
    v_mfma_f32_32x32x16_bf16 v[192:207], a[240:243], v[124:127], v[192:207]
    v_mfma_f32_32x32x16_bf16 v[208:223], a[244:247], v[124:127], v[208:223]
    buffer_load_dwordx4 v[124:127], v8, s[52:55], s91 offen offset:2560
    s_add_u32 s91, s91, 4096
    s_waitcnt vmcnt(18) lgkmcnt(0)
    v_mfma_f32_32x32x16_bf16 v[192:207], a[248:251], v[228:231], v[192:207]
    v_mfma_f32_32x32x16_bf16 v[208:223], a[252:255], v[228:231], v[208:223]
    s_waitcnt vmcnt(17)
    v_mfma_f32_32x32x16_bf16 v[224:239], a[0:3], v[128:131], 0
    s_nop 8
    ds_write_b128 v28, v[192:195] offset:0
    v_mfma_f32_32x32x16_bf16 v[240:255], a[4:7], v[128:131], 0
    buffer_load_dwordx4 v[128:131], v8, s[52:55], s91 offen offset:512
    s_waitcnt vmcnt(17)
    v_mfma_f32_32x32x16_bf16 v[224:239], a[8:11], v[12:15], v[224:239]
    ds_write_b128 v29, v[196:199] offset:0
    v_mfma_f32_32x32x16_bf16 v[240:255], a[12:15], v[12:15], v[240:255]
    buffer_load_dwordx4 v[12:15], v8, s[52:55], s91 offen offset:2560
    s_add_u32 s91, s91, 4096
    s_cmp_eq_u32 s91, s92
    s_cselect_b32 s91, s93, s91
    s_waitcnt vmcnt(17)
    v_mfma_f32_32x32x16_bf16 v[224:239], a[16:19], v[40:43], v[224:239]
    ds_write_b128 v30, v[200:203] offset:0
    v_mfma_f32_32x32x16_bf16 v[240:255], a[20:23], v[40:43], v[240:255]
    buffer_load_dwordx4 v[40:43], v8, s[52:55], s91 offen offset:512
    s_waitcnt vmcnt(17)
    v_mfma_f32_32x32x16_bf16 v[224:239], a[24:27], v[48:51], v[224:239]
    ds_write_b128 v31, v[204:207] offset:0
    v_mfma_f32_32x32x16_bf16 v[240:255], a[28:31], v[48:51], v[240:255]
    buffer_load_dwordx4 v[48:51], v8, s[52:55], s91 offen offset:2560
    s_add_u32 s91, s91, 4096
    s_waitcnt vmcnt(17)
    v_mfma_f32_32x32x16_bf16 v[224:239], a[32:35], v[52:55], v[224:239]
    ds_write_b128 v28, v[208:211] offset:128
    v_mfma_f32_32x32x16_bf16 v[240:255], a[36:39], v[52:55], v[240:255]
    buffer_load_dwordx4 v[52:55], v8, s[52:55], s91 offen offset:512
    s_waitcnt vmcnt(17)
    v_mfma_f32_32x32x16_bf16 v[224:239], a[40:43], v[56:59], v[224:239]
    ds_write_b128 v29, v[212:215] offset:128
    v_mfma_f32_32x32x16_bf16 v[240:255], a[44:47], v[56:59], v[240:255]
    buffer_load_dwordx4 v[56:59], v8, s[52:55], s91 offen offset:2560
    s_add_u32 s91, s91, 4096
    s_cmp_eq_u32 s91, s92
    s_cselect_b32 s91, s93, s91
    s_waitcnt vmcnt(17)
    v_mfma_f32_32x32x16_bf16 v[224:239], a[48:51], v[60:63], v[224:239]
    ds_write_b128 v30, v[216:219] offset:128
    v_mfma_f32_32x32x16_bf16 v[240:255], a[52:55], v[60:63], v[240:255]
    buffer_load_dwordx4 v[60:63], v8, s[52:55], s91 offen offset:512
    s_waitcnt vmcnt(17)
    v_mfma_f32_32x32x16_bf16 v[224:239], a[56:59], v[64:67], v[224:239]
    ds_write_b128 v31, v[220:223] offset:128
    v_mfma_f32_32x32x16_bf16 v[240:255], a[60:63], v[64:67], v[240:255]
    buffer_load_dwordx4 v[64:67], v8, s[52:55], s91 offen offset:2560
    s_add_u32 s91, s91, 4096
    s_waitcnt vmcnt(17)
    v_mfma_f32_32x32x16_bf16 v[224:239], a[64:67], v[68:71], v[224:239]
    v_mfma_f32_32x32x16_bf16 v[240:255], a[68:71], v[68:71], v[240:255]
    buffer_load_dwordx4 v[68:71], v8, s[52:55], s91 offen offset:512
    s_waitcnt vmcnt(17)
    v_mfma_f32_32x32x16_bf16 v[224:239], a[72:75], v[80:83], v[224:239]
    v_mfma_f32_32x32x16_bf16 v[240:255], a[76:79], v[80:83], v[240:255]
    buffer_load_dwordx4 v[80:83], v8, s[52:55], s91 offen offset:2560
    s_add_u32 s91, s91, 4096
    s_cmp_eq_u32 s91, s92
    s_cselect_b32 s91, s93, s91
    s_waitcnt vmcnt(17)
    v_mfma_f32_32x32x16_bf16 v[224:239], a[80:83], v[84:87], v[224:239]
    s_waitcnt lgkmcnt(0)
    s_barrier
    ds_read_b128 v[192:195], v32 offset:0
    ds_read_b128 v[196:199], v33 offset:0
    ds_read_b128 v[200:203], v32 offset:40960
    ds_read_b128 v[204:207], v33 offset:40960
    v_mfma_f32_32x32x16_bf16 v[240:255], a[84:87], v[84:87], v[240:255]
    buffer_load_dwordx4 v[84:87], v8, s[52:55], s91 offen offset:512
    ds_read_b128 v[208:211], v34 offset:0
    ds_read_b128 v[212:215], v35 offset:0
    ds_read_b128 v[216:219], v34 offset:40960
    ds_read_b128 v[220:223], v35 offset:40960
    s_waitcnt vmcnt(17)
    v_mfma_f32_32x32x16_bf16 v[224:239], a[88:91], v[88:91], v[224:239]
    v_mfma_f32_32x32x16_bf16 v[240:255], a[92:95], v[88:91], v[240:255]
    buffer_load_dwordx4 v[88:91], v8, s[52:55], s91 offen offset:2560
    s_add_u32 s91, s91, 4096
    s_waitcnt vmcnt(17)
    v_mfma_f32_32x32x16_bf16 v[224:239], a[96:99], v[92:95], v[224:239]
    v_mfma_f32_32x32x16_bf16 v[240:255], a[100:103], v[92:95], v[240:255]
    buffer_load_dwordx4 v[92:95], v8, s[52:55], s91 offen offset:512
    s_waitcnt vmcnt(17)
    v_mfma_f32_32x32x16_bf16 v[224:239], a[104:107], v[96:99], v[224:239]
    v_mfma_f32_32x32x16_bf16 v[240:255], a[108:111], v[96:99], v[240:255]
    buffer_load_dwordx4 v[96:99], v8, s[52:55], s91 offen offset:2560
    s_lshr_b32 s26, s14, 5
    s_lshl_b32 s26, s26, 18
    s_and_b32 s27, s14, 31
    s_lshl_b32 s27, s27, 5
    s_add_u32 s26, s26, s27
    s_lshl_b32 s27, s12, 16
    s_add_u32 s26, s26, s27
    s_add_u32 s26, s26, 2097152
    v_lshlrev_b32 v136, 10, v1
    s_lshl_b32 s27, s12, 10
    s_add_u32 m0, s27, 76928
    s_nop 0
    buffer_load_dwordx4 v136, s[8:11], s26 offen lds
    s_add_u32 s26, s26, 16
    s_add_u32 m0, s27, 158848
    s_nop 0
    buffer_load_dwordx4 v136, s[8:11], s26 offen lds
    s_mul_i32 s27, s19, 81920
    s_add_u32 s27, s27, 76416
    v_lshl_add_u32 v137, v1, 3, s27
    v_mov_b32 v138, 0
    v_mov_b32 v139, 0
    ds_write_b64 v137, v[138:139]
    global_load_dwordx4 v[136:139], v3, s[48:49]
    global_load_dwordx4 v[140:143], v3, s[48:49] offset:64
    s_waitcnt vmcnt(21)
    v_mfma_f32_32x32x16_bf16 v[224:239], a[112:115], v[104:107], v[224:239]
    v_mfma_f32_32x32x16_bf16 v[240:255], a[116:119], v[104:107], v[240:255]
    s_waitcnt vmcnt(20)
    v_mfma_f32_32x32x16_bf16 v[224:239], a[120:123], v[108:111], v[224:239]
    v_mfma_f32_32x32x16_bf16 v[240:255], a[124:127], v[108:111], v[240:255]
    s_waitcnt lgkmcnt(1)
    s_barrier
    v_add_f32 v192, v192, v200
    v_add_f32 v193, v193, v201
    v_add_f32 v208, v208, v216
    v_add_f32 v209, v209, v217
    v_add_f32 v194, v194, v202
    v_add_f32 v195, v195, v203
    v_add_f32 v210, v210, v218
    v_add_f32 v211, v211, v219
    s_waitcnt vmcnt(19)
    v_mfma_f32_32x32x16_bf16 v[224:239], a[128:131], v[116:119], v[224:239]
    v_mfma_f32_32x32x16_bf16 v[240:255], a[132:135], v[116:119], v[240:255]
    v_add_f32 v196, v196, v204
    v_add_f32 v197, v197, v205
    v_add_f32 v212, v212, v220
    v_add_f32 v213, v213, v221
    v_add_f32 v198, v198, v206
    v_add_f32 v199, v199, v207
    v_add_f32 v214, v214, v222
    v_add_f32 v215, v215, v223
    s_waitcnt vmcnt(18)
    v_mfma_f32_32x32x16_bf16 v[224:239], a[136:139], v[124:127], v[224:239]
    v_add_f32 v192, v192, v208
    v_add_f32 v193, v193, v209
    v_add_f32 v194, v194, v210
    v_add_f32 v195, v195, v211
    v_mfma_f32_32x32x16_bf16 v[240:255], a[140:143], v[124:127], v[240:255]
    v_add_f32 v196, v196, v212
    v_add_f32 v197, v197, v213
    v_add_f32 v198, v198, v214
    v_add_f32 v199, v199, v215
    s_waitcnt vmcnt(17)
    v_mfma_f32_32x32x16_bf16 v[224:239], a[144:147], v[128:131], v[224:239]
    v_cvt_pk_bf16_f32 v208, v192, v193
    v_cvt_pk_bf16_f32 v210, v194, v195
    v_cvt_pk_bf16_f32 v212, v196, v197
    v_cvt_pk_bf16_f32 v214, v198, v199
    v_lshlrev_b32 v192, 16, v208
    v_and_b32 v193, s59, v208
    v_lshlrev_b32 v194, 16, v210
    v_and_b32 v195, s59, v210
    v_mfma_f32_32x32x16_bf16 v[240:255], a[148:151], v[128:131], v[240:255]
    v_lshlrev_b32 v196, 16, v212
    v_and_b32 v197, s59, v212
    v_lshlrev_b32 v198, 16, v214
    v_and_b32 v199, s59, v214
    s_waitcnt vmcnt(16)
    v_mfma_f32_32x32x16_bf16 v[224:239], a[152:155], v[12:15], v[224:239]
    v_add_f32 v192, v192, v72
    v_add_f32 v193, v193, v73
    v_add_f32 v194, v194, v74
    v_add_f32 v195, v195, v75
    v_mfma_f32_32x32x16_bf16 v[240:255], a[156:159], v[12:15], v[240:255]
    v_add_f32 v196, v196, v76
    v_add_f32 v197, v197, v77
    v_add_f32 v198, v198, v78
    v_add_f32 v199, v199, v79
    v_cvt_pk_bf16_f32 v208, v192, v193
    v_cvt_pk_bf16_f32 v210, v194, v195
    v_cvt_pk_bf16_f32 v212, v196, v197
    v_cvt_pk_bf16_f32 v214, v198, v199
    s_waitcnt vmcnt(15)
    v_mfma_f32_32x32x16_bf16 v[224:239], a[160:163], v[40:43], v[224:239]
    v_lshlrev_b32 v192, 16, v208
    v_and_b32 v193, s59, v208
    v_lshlrev_b32 v194, 16, v210
    v_and_b32 v195, s59, v210
    v_mfma_f32_32x32x16_bf16 v[240:255], a[164:167], v[40:43], v[240:255]
    v_lshlrev_b32 v196, 16, v212
    v_and_b32 v197, s59, v212
    v_lshlrev_b32 v198, 16, v214
    v_and_b32 v199, s59, v214
    s_waitcnt vmcnt(14)
    v_mfma_f32_32x32x16_bf16 v[224:239], a[168:171], v[48:51], v[224:239]
    v_mul_f32 v200, v192, v192
    v_mul_f32 v201, v193, v193
    v_mul_f32 v202, v194, v194
    v_mul_f32 v203, v195, v195
    v_mul_f32 v204, v196, v196
    v_mul_f32 v205, v197, v197
    v_mul_f32 v206, v198, v198
    v_mul_f32 v207, v199, v199
    v_mfma_f32_32x32x16_bf16 v[240:255], a[172:175], v[48:51], v[240:255]
    v_fma_f32 v200, v200, s38, v10
    v_fma_f32 v201, v201, s39, v11
    v_fma_f32 v202, v202, s38, v10
    v_fma_f32 v203, v203, s39, v11
    s_waitcnt vmcnt(13)
    v_mfma_f32_32x32x16_bf16 v[224:239], a[176:179], v[52:55], v[224:239]
    v_fma_f32 v204, v204, s38, v10
    v_fma_f32 v205, v205, s39, v11
    v_fma_f32 v206, v206, s38, v10
    v_fma_f32 v207, v207, s39, v11
    v_mul_f32 v200, v192, v200
    v_mul_f32 v201, v193, v201
    v_mul_f32 v202, v194, v202
    v_mul_f32 v203, v195, v203
    v_mfma_f32_32x32x16_bf16 v[240:255], a[180:183], v[52:55], v[240:255]
    v_mul_f32 v204, v196, v204
    v_mul_f32 v205, v197, v205
    v_mul_f32 v206, v198, v206
    v_mul_f32 v207, v199, v207
    s_waitcnt vmcnt(12)
    v_mfma_f32_32x32x16_bf16 v[224:239], a[184:187], v[56:59], v[224:239]
    v_exp_f32 v200, v200
    v_exp_f32 v201, v201
    v_mfma_f32_32x32x16_bf16 v[240:255], a[188:191], v[56:59], v[240:255]
    v_exp_f32 v202, v202
    v_exp_f32 v203, v203
    v_exp_f32 v204, v204
    s_waitcnt vmcnt(11)
    v_mfma_f32_32x32x16_bf16 v[224:239], a[192:195], v[60:63], v[224:239]
    v_exp_f32 v205, v205
    v_exp_f32 v206, v206
    v_exp_f32 v207, v207
    v_mfma_f32_32x32x16_bf16 v[240:255], a[196:199], v[60:63], v[240:255]
    v_add_f32 v200, v200, s44
    v_add_f32 v201, v201, s45
    v_add_f32 v202, v202, s44
    v_add_f32 v203, v203, s45
    s_waitcnt vmcnt(10)
    v_mfma_f32_32x32x16_bf16 v[224:239], a[200:203], v[64:67], v[224:239]
    v_add_f32 v204, v204, s44
    v_add_f32 v205, v205, s45
    v_add_f32 v206, v206, s44
    v_add_f32 v207, v207, s45
    v_rcp_f32 v200, v200
    s_waitcnt vmcnt(9)
    v_mfma_f32_32x32x16_bf16 v[224:239], a[208:211], v[68:71], v[224:239]
    v_rcp_f32 v201, v201
    v_rcp_f32 v202, v202
    v_rcp_f32 v203, v203
    s_waitcnt vmcnt(8)
    v_mfma_f32_32x32x16_bf16 v[224:239], a[216:219], v[80:83], v[224:239]
    v_rcp_f32 v204, v204
    v_rcp_f32 v205, v205
    v_rcp_f32 v206, v206
    s_waitcnt vmcnt(7)
    v_mfma_f32_32x32x16_bf16 v[224:239], a[224:227], v[84:87], v[224:239]
    v_rcp_f32 v207, v207
    v_mul_f32 v192, v192, v200
    v_mul_f32 v193, v193, v201
    v_mul_f32 v194, v194, v202
    v_mul_f32 v195, v195, v203
    s_waitcnt vmcnt(6)
    v_mfma_f32_32x32x16_bf16 v[224:239], a[232:235], v[88:91], v[224:239]
    v_mul_f32 v196, v196, v204
    v_mul_f32 v197, v197, v205
    v_mul_f32 v198, v198, v206
    v_mul_f32 v199, v199, v207
    v_cvt_pk_bf16_f32 v208, v192, v193
    v_cvt_pk_bf16_f32 v209, v194, v195
    v_cvt_pk_bf16_f32 v210, v196, v197
    v_cvt_pk_bf16_f32 v211, v198, v199
    s_waitcnt vmcnt(5)
    v_mfma_f32_32x32x16_bf16 v[224:239], a[240:243], v[92:95], v[224:239]
    global_store_dwordx4 v9, v[208:211], s[80:81] offset:0 sc1
    s_add_u32 m0, s13, 0
    s_nop 0
    buffer_load_dwordx4 v20, s[84:87], s88 offen offset:0 lds
    s_waitcnt vmcnt(6)
    v_mfma_f32_32x32x16_bf16 v[224:239], a[248:251], v[96:99], v[224:239]
    v_mfma_f32_32x32x16_bf16 v[240:255], a[204:207], v[64:67], v[240:255]
    buffer_load_dwordx4 v21, s[84:87], s88 offen offset:1024 lds
    v_mfma_f32_32x32x16_bf16 v[240:255], a[212:215], v[68:71], v[240:255]
    s_nop 8
    ds_write_b128 v28, v[224:227]
    v_mfma_f32_32x32x16_bf16 v[240:255], a[220:223], v[80:83], v[240:255]
    ds_write_b128 v29, v[228:231]
    buffer_load_dwordx4 v22, s[84:87], s88 offen offset:2048 lds
    v_mfma_f32_32x32x16_bf16 v[240:255], a[228:231], v[84:87], v[240:255]
    ds_write_b128 v30, v[232:235]
    v_mfma_f32_32x32x16_bf16 v[240:255], a[236:239], v[88:91], v[240:255]
    ds_write_b128 v31, v[236:239]
    buffer_load_dwordx4 v23, s[84:87], s88 offen offset:3072 lds
    s_add_u32 s88, s88, 131072
    v_mfma_f32_32x32x16_bf16 v[240:255], a[244:247], v[92:95], v[240:255]
    v_mfma_f32_32x32x16_bf16 v[240:255], a[252:255], v[96:99], v[240:255]
    s_add_u32 m0, s13, 4096
    s_nop 0
    buffer_load_dwordx4 v20, s[84:87], s88 offen offset:0 lds
    s_nop 8
    ds_write_b128 v28, v[240:243] offset:128
    ds_write_b128 v29, v[244:247] offset:128
    ds_write_b128 v30, v[248:251] offset:128
    ds_write_b128 v31, v[252:255] offset:128
    s_waitcnt vmcnt(8) lgkmcnt(0)
    s_barrier
    ds_read_b128 v[224:227], v32 offset:0
    ds_read_b128 v[228:231], v33 offset:0
    ds_read_b128 v[232:235], v32 offset:40960
    ds_read_b128 v[236:239], v33 offset:40960
    ds_read_b128 v[240:243], v34 offset:0
    ds_read_b128 v[244:247], v35 offset:0
    ds_read_b128 v[248:251], v34 offset:40960
    ds_read_b128 v[252:255], v35 offset:40960
    ds_read2_b64 v[12:15], v36 offset0:232 offset1:233
    ds_read_b128 v[56:59], v26 offset:320
    ds_read_b128 v[60:63], v26 offset:832
    ds_read_b128 v[64:67], v26 offset:1344
    ds_read_b128 v[68:71], v26 offset:1856
    ds_read_b128 v[80:83], v26 offset:2368
    ds_read_b128 v[84:87], v26 offset:2880
    ds_read_b128 v[88:91], v26 offset:3392
    ds_read_b128 v[92:95], v26 offset:3904
    ds_read2_b64 v[40:43], v36 offset0:200 offset1:201
    ds_read_b128 v[96:99], v26 offset:64
    ds_read_b128 v[104:107], v26 offset:576
    s_waitcnt lgkmcnt(12)
    s_waitcnt lgkmcnt(12)
    v_pk_add_f32 v[224:225], v[224:225], v[232:233]
    v_pk_add_f32 v[240:241], v[240:241], v[248:249]
    v_pk_add_f32 v[226:227], v[226:227], v[234:235]
    v_pk_add_f32 v[242:243], v[242:243], v[250:251]
    v_pk_add_f32 v[228:229], v[228:229], v[236:237]
    v_pk_add_f32 v[244:245], v[244:245], v[252:253]
    v_pk_add_f32 v[230:231], v[230:231], v[238:239]
    v_pk_add_f32 v[246:247], v[246:247], v[254:255]
    v_pk_add_f32 v[224:225], v[224:225], v[240:241]
    v_pk_add_f32 v[226:227], v[226:227], v[242:243]
    v_pk_add_f32 v[228:229], v[228:229], v[244:245]
    v_pk_add_f32 v[230:231], v[230:231], v[246:247]
    v_cvt_pk_bf16_f32 v240, v224, v225
    v_cvt_pk_bf16_f32 v242, v226, v227
    v_cvt_pk_bf16_f32 v244, v228, v229
    v_cvt_pk_bf16_f32 v246, v230, v231
    v_lshlrev_b32 v224, 16, v240
    v_and_b32 v225, s59, v240
    v_lshlrev_b32 v226, 16, v242
    v_and_b32 v227, s59, v242
    v_lshlrev_b32 v228, 16, v244
    v_and_b32 v229, s59, v244
    v_lshlrev_b32 v230, 16, v246
    v_and_b32 v231, s59, v246
    v_pk_add_f32 v[224:225], v[224:225], v[72:73]
    v_pk_add_f32 v[226:227], v[226:227], v[74:75]
    v_pk_add_f32 v[228:229], v[228:229], v[76:77]
    v_pk_add_f32 v[230:231], v[230:231], v[78:79]
    v_cvt_pk_bf16_f32 v240, v224, v225
    v_cvt_pk_bf16_f32 v242, v226, v227
    v_cvt_pk_bf16_f32 v244, v228, v229
    v_cvt_pk_bf16_f32 v246, v230, v231
    v_lshlrev_b32 v224, 16, v240
    v_and_b32 v225, s59, v240
    v_lshlrev_b32 v226, 16, v242
    v_and_b32 v227, s59, v242
    v_lshlrev_b32 v228, 16, v244
    v_and_b32 v229, s59, v244
    v_lshlrev_b32 v230, 16, v246
    v_and_b32 v231, s59, v246
    v_pk_mul_f32 v[232:233], v[224:225], v[224:225]
    v_pk_mul_f32 v[234:235], v[226:227], v[226:227]
    v_pk_mul_f32 v[236:237], v[228:229], v[228:229]
    v_pk_mul_f32 v[238:239], v[230:231], v[230:231]
    v_pk_fma_f32 v[232:233], v[232:233], s[38:39], v[10:11]
    v_pk_fma_f32 v[234:235], v[234:235], s[38:39], v[10:11]
    v_pk_fma_f32 v[236:237], v[236:237], s[38:39], v[10:11]
    v_pk_fma_f32 v[238:239], v[238:239], s[38:39], v[10:11]
    v_pk_mul_f32 v[232:233], v[224:225], v[232:233]
    v_pk_mul_f32 v[234:235], v[226:227], v[234:235]
    v_pk_mul_f32 v[236:237], v[228:229], v[236:237]
    v_pk_mul_f32 v[238:239], v[230:231], v[238:239]
    v_exp_f32 v232, v232
    v_exp_f32 v233, v233
    v_exp_f32 v234, v234
    v_exp_f32 v235, v235
    v_exp_f32 v236, v236
    v_exp_f32 v237, v237
    v_exp_f32 v238, v238
    v_exp_f32 v239, v239
    v_pk_add_f32 v[232:233], v[232:233], s[44:45]
    v_pk_add_f32 v[234:235], v[234:235], s[44:45]
    v_pk_add_f32 v[236:237], v[236:237], s[44:45]
    v_pk_add_f32 v[238:239], v[238:239], s[44:45]
    v_rcp_f32 v232, v232
    v_rcp_f32 v233, v233
    v_rcp_f32 v234, v234
    v_rcp_f32 v235, v235
    v_rcp_f32 v236, v236
    v_rcp_f32 v237, v237
    v_rcp_f32 v238, v238
    v_rcp_f32 v239, v239
    v_pk_mul_f32 v[224:225], v[224:225], v[232:233]
    v_pk_mul_f32 v[226:227], v[226:227], v[234:235]
    v_pk_mul_f32 v[228:229], v[228:229], v[236:237]
    v_pk_mul_f32 v[230:231], v[230:231], v[238:239]
    v_cvt_pk_bf16_f32 v240, v224, v225
    v_cvt_pk_bf16_f32 v241, v226, v227
    v_cvt_pk_bf16_f32 v242, v228, v229
    v_cvt_pk_bf16_f32 v243, v230, v231
    global_store_dwordx4 v9, v[240:243], s[80:81] offset:512 sc1
L_join:
    ds_read_b128 v[8:11], v26 offset:1088
    ds_read_b128 v[28:31], v26 offset:1600
    ds_read_b128 v[32:35], v26 offset:2112
    ds_read_b128 v[72:75], v26 offset:2624
    ds_read_b128 v[76:79], v26 offset:3136
    ds_read_b128 v[108:111], v26 offset:3648
    ds_read2_b64 v[48:51], v36 offset0:168 offset1:169
    ds_read2_b64 v[52:55], v36 offset0:136 offset1:137
    s_waitcnt lgkmcnt(15)
    v_mfma_f32_16x16x32_bf16 v[192:195], v[12:15], v[56:59], 0
    s_add_u32 m0, s13, 4096
    s_nop 0
    buffer_load_dwordx4 v21, s[84:87], s88 offen offset:1024 lds
    s_waitcnt lgkmcnt(15)
    v_mfma_f32_16x16x32_bf16 v[196:199], v[12:15], v[60:63], 0
    ds_read_b128 v[116:119], v26 offset:256
    s_waitcnt lgkmcnt(15)
    v_mfma_f32_16x16x32_bf16 v[200:203], v[12:15], v[64:67], 0
    buffer_load_dwordx4 v22, s[84:87], s88 offen offset:2048 lds
    s_waitcnt lgkmcnt(15)
    v_mfma_f32_16x16x32_bf16 v[204:207], v[12:15], v[68:71], 0
    ds_read_b128 v[124:127], v26 offset:768
    s_waitcnt lgkmcnt(15)
    v_mfma_f32_16x16x32_bf16 v[208:211], v[12:15], v[80:83], 0
    buffer_load_dwordx4 v23, s[84:87], s88 offen offset:3072 lds
    s_add_u32 s88, s88, 131072
    s_cmp_eq_u32 s88, s89
    s_cselect_b32 s88, s90, s88
    s_waitcnt lgkmcnt(15)
    v_mfma_f32_16x16x32_bf16 v[212:215], v[12:15], v[84:87], 0
    ds_read_b128 v[128:131], v26 offset:1280
    s_waitcnt lgkmcnt(15)
    v_mfma_f32_16x16x32_bf16 v[216:219], v[12:15], v[88:91], 0
    s_add_u32 m0, s13, 8192
    s_nop 0
    buffer_load_dwordx4 v20, s[84:87], s88 offen offset:0 lds
    s_waitcnt lgkmcnt(14)
    v_mfma_f32_16x16x32_bf16 v[220:223], v[12:15], v[92:95], 0
    ds_read_b128 v[144:147], v26 offset:1792
    ds_read2_b64 v[12:15], v36 offset0:104 offset1:105
    s_waitcnt lgkmcnt(14)
    v_mfma_f32_16x16x32_bf16 v[192:195], v[40:43], v[96:99], v[192:195]
    buffer_load_dwordx4 v21, s[84:87], s88 offen offset:1024 lds
    s_waitcnt lgkmcnt(13)
    v_mfma_f32_16x16x32_bf16 v[196:199], v[40:43], v[104:107], v[196:199]
    ds_read_b128 v[92:95], v26 offset:2304
    s_waitcnt lgkmcnt(13)
    v_mfma_f32_16x16x32_bf16 v[200:203], v[40:43], v[8:11], v[200:203]
    buffer_load_dwordx4 v22, s[84:87], s88 offen offset:2048 lds
    s_waitcnt lgkmcnt(12)
    v_mfma_f32_16x16x32_bf16 v[204:207], v[40:43], v[28:31], v[204:207]
    ds_read_b128 v[148:151], v26 offset:2816
    s_waitcnt lgkmcnt(12)
    v_mfma_f32_16x16x32_bf16 v[208:211], v[40:43], v[32:35], v[208:211]
    buffer_load_dwordx4 v23, s[84:87], s88 offen offset:3072 lds
    s_add_u32 s88, s88, 131072
    s_waitcnt lgkmcnt(11)
    v_mfma_f32_16x16x32_bf16 v[212:215], v[40:43], v[72:75], v[212:215]
    ds_read_b128 v[152:155], v26 offset:3328
    s_waitcnt lgkmcnt(11)
    v_mfma_f32_16x16x32_bf16 v[216:219], v[40:43], v[76:79], v[216:219]
    s_add_u32 m0, s13, 12288
    s_nop 0
    buffer_load_dwordx4 v20, s[84:87], s88 offen offset:0 lds
    s_waitcnt lgkmcnt(10)
    v_mfma_f32_16x16x32_bf16 v[220:223], v[40:43], v[108:111], v[220:223]
    ds_read_b128 v[156:159], v26 offset:3840
    ds_read2_b64 v[40:43], v36 offset0:72 offset1:73
    s_waitcnt lgkmcnt(11)
    v_mfma_f32_16x16x32_bf16 v[196:199], v[48:51], v[56:59], v[196:199]
    ds_read_b128 v[108:111], v26 offset:0
    buffer_load_dwordx4 v21, s[84:87], s88 offen offset:1024 lds
    s_waitcnt vmcnt(9)
    s_barrier
    s_cmp_lg_u32 s12, 0
    s_cbranch_scc1 L_fl3
    s_lshl_b32 s26, s16, 5
    s_add_u32 s26, s26, s15
    s_add_u32 s27, s14, 256
    s_cmp_ge_u32 s25, 28
    s_cselect_b32 s26, s27, s26
    s_lshl_b32 s26, s26, 3
    s_add_u32 s26, s26, 12648448
    v_mov_b32 v160, s26
    s_or_b32 s26, s100, 2
    v_mov_b32 v162, s26
    v_mov_b32 v163, s101
    s_mov_b64 exec, 1
    global_store_dwordx2 v160, v[162:163], s[80:81] sc1
    s_mov_b64 exec, -1
L_fl3:
    v_mfma_f32_16x16x32_bf16 v[200:203], v[48:51], v[60:63], v[200:203]
    v_mfma_f32_16x16x32_bf16 v[204:207], v[48:51], v[64:67], v[204:207]
    ds_read_b128 v[160:163], v26 offset:512
    buffer_load_dwordx4 v22, s[84:87], s88 offen offset:2048 lds
    v_mfma_f32_16x16x32_bf16 v[208:211], v[48:51], v[68:71], v[208:211]
    v_mfma_f32_16x16x32_bf16 v[212:215], v[48:51], v[80:83], v[212:215]
    ds_read_b128 v[164:167], v26 offset:1024
    buffer_load_dwordx4 v23, s[84:87], s88 offen offset:3072 lds
    s_add_u32 s88, s88, 131072
    s_cmp_eq_u32 s88, s89
    s_cselect_b32 s88, s90, s88
    v_mfma_f32_16x16x32_bf16 v[216:219], v[48:51], v[84:87], v[216:219]
    v_mfma_f32_16x16x32_bf16 v[220:223], v[48:51], v[88:91], v[220:223]
    ds_read_b128 v[168:171], v26 offset:1536
    s_waitcnt vmcnt(15)
    ds_read_b64_tr_b16 a[0:1], v46 offset:0
    ds_read_b64_tr_b16 a[2:3], v46 offset:512
    ds_read_b64_tr_b16 a[4:5], v47 offset:0
    ds_read_b64_tr_b16 a[6:7], v47 offset:512
    ds_read2_b64 v[48:51], v36 offset0:40 offset1:41
    s_waitcnt lgkmcnt(15)
    v_mfma_f32_16x16x32_bf16 v[196:199], v[52:55], v[96:99], v[196:199]
    ds_read_b128 v[88:91], v26 offset:2048
    s_waitcnt vmcnt(13)
    ds_read_b64_tr_b16 a[8:9], v46 offset:2048
    ds_read_b64_tr_b16 a[10:11], v46 offset:2560
    ds_read_b64_tr_b16 a[12:13], v47 offset:2048
    ds_read_b64_tr_b16 a[14:15], v47 offset:2560
    v_mfma_f32_16x16x32_bf16 v[200:203], v[52:55], v[104:107], v[200:203]
    v_mfma_f32_16x16x32_bf16 v[204:207], v[52:55], v[8:11], v[204:207]
    ds_read_b128 v[172:175], v26 offset:2560
    s_waitcnt lgkmcnt(7)
    s_add_u32 m0, s13, 0
    s_nop 0
    buffer_load_dwordx4 v20, s[84:87], s88 offen offset:0 lds
    v_mfma_f32_16x16x32_bf16 v[208:211], v[52:55], v[28:31], v[208:211]
    buffer_load_dwordx4 v21, s[84:87], s88 offen offset:1024 lds
    s_waitcnt vmcnt(12)
    ds_read_b64_tr_b16 a[16:17], v46 offset:4096
    ds_read_b64_tr_b16 a[18:19], v46 offset:4608
    ds_read_b64_tr_b16 a[20:21], v47 offset:4096
    ds_read_b64_tr_b16 a[22:23], v47 offset:4608
    v_mfma_f32_16x16x32_bf16 v[212:215], v[52:55], v[32:35], v[212:215]
    ds_read_b128 v[176:179], v26 offset:3072
    v_mfma_f32_16x16x32_bf16 v[216:219], v[52:55], v[72:75], v[216:219]
    s_waitcnt lgkmcnt(6)
    buffer_load_dwordx4 v22, s[84:87], s88 offen offset:2048 lds
    v_mfma_f32_16x16x32_bf16 v[220:223], v[52:55], v[76:79], v[220:223]
    ds_read_b128 v[180:183], v26 offset:3584
    buffer_load_dwordx4 v23, s[84:87], s88 offen offset:3072 lds
    s_add_u32 s88, s88, 131072
    s_waitcnt vmcnt(12)
    ds_read_b64_tr_b16 a[24:25], v46 offset:6144
    ds_read_b64_tr_b16 a[26:27], v46 offset:6656
    ds_read_b64_tr_b16 a[28:29], v47 offset:6144
    ds_read_b64_tr_b16 a[30:31], v47 offset:6656
    ds_read2_b64 v[52:55], v36 offset0:8 offset1:9
    s_waitcnt lgkmcnt(15)
    v_mfma_f32_16x16x32_bf16 v[200:203], v[12:15], v[56:59], v[200:203]
    v_mfma_f32_16x16x32_bf16 v[204:207], v[12:15], v[60:63], v[204:207]
    s_waitcnt lgkmcnt(7)
    s_add_u32 m0, s13, 4096
    s_nop 0
    buffer_load_dwordx4 v20, s[84:87], s88 offen offset:0 lds
    v_mfma_f32_16x16x32_bf16 v[208:211], v[12:15], v[64:67], v[208:211]
    buffer_load_dwordx4 v21, s[84:87], s88 offen offset:1024 lds
    s_waitcnt vmcnt(12)
    ds_read_b64_tr_b16 a[32:33], v46 offset:8192
    ds_read_b64_tr_b16 a[34:35], v46 offset:8704
    ds_read_b64_tr_b16 a[36:37], v47 offset:8192
    ds_read_b64_tr_b16 a[38:39], v47 offset:8704
    v_mfma_f32_16x16x32_bf16 v[212:215], v[12:15], v[68:71], v[212:215]
    v_mfma_f32_16x16x32_bf16 v[216:219], v[12:15], v[80:83], v[216:219]
    s_waitcnt lgkmcnt(5)
    buffer_load_dwordx4 v22, s[84:87], s88 offen offset:2048 lds
    v_mfma_f32_16x16x32_bf16 v[220:223], v[12:15], v[84:87], v[220:223]
    buffer_load_dwordx4 v23, s[84:87], s88 offen offset:3072 lds
    s_add_u32 s88, s88, 131072
    s_cmp_eq_u32 s88, s89
    s_cselect_b32 s88, s90, s88
    ds_read2_b64 v[12:15], v27 offset0:232 offset1:233
    s_waitcnt lgkmcnt(15)
    v_mfma_f32_16x16x32_bf16 v[200:203], v[40:43], v[96:99], v[200:203]
    s_waitcnt vmcnt(12)
    ds_read_b64_tr_b16 a[40:41], v46 offset:10240
    ds_read_b64_tr_b16 a[42:43], v46 offset:10752
    ds_read_b64_tr_b16 a[44:45], v47 offset:10240
    ds_read_b64_tr_b16 a[46:47], v47 offset:10752
    v_mfma_f32_16x16x32_bf16 v[204:207], v[40:43], v[104:107], v[204:207]
    v_mfma_f32_16x16x32_bf16 v[208:211], v[40:43], v[8:11], v[208:211]
    s_waitcnt lgkmcnt(5)
    s_add_u32 m0, s13, 8192
    s_nop 0
    buffer_load_dwordx4 v20, s[84:87], s88 offen offset:0 lds
    v_mfma_f32_16x16x32_bf16 v[212:215], v[40:43], v[28:31], v[212:215]
    buffer_load_dwordx4 v21, s[84:87], s88 offen offset:1024 lds
    s_waitcnt vmcnt(12)
    ds_read_b64_tr_b16 a[48:49], v46 offset:12288
    ds_read_b64_tr_b16 a[50:51], v46 offset:12800
    ds_read_b64_tr_b16 a[52:53], v47 offset:12288
    ds_read_b64_tr_b16 a[54:55], v47 offset:12800
    v_mfma_f32_16x16x32_bf16 v[216:219], v[40:43], v[32:35], v[216:219]
    v_mfma_f32_16x16x32_bf16 v[220:223], v[40:43], v[72:75], v[220:223]
    s_waitcnt lgkmcnt(4)
    buffer_load_dwordx4 v22, s[84:87], s88 offen offset:2048 lds
    buffer_load_dwordx4 v23, s[84:87], s88 offen offset:3072 lds
    s_add_u32 s88, s88, 131072
    ds_read2_b64 v[40:43], v27 offset0:200 offset1:201
    s_waitcnt lgkmcnt(15)
    v_mfma_f32_16x16x32_bf16 v[204:207], v[48:51], v[56:59], v[204:207]
    s_waitcnt vmcnt(12)
    ds_read_b64_tr_b16 a[56:57], v46 offset:14336
    ds_read_b64_tr_b16 a[58:59], v46 offset:14848
    ds_read_b64_tr_b16 a[60:61], v47 offset:14336
    ds_read_b64_tr_b16 a[62:63], v47 offset:14848
    v_mfma_f32_16x16x32_bf16 v[208:211], v[48:51], v[60:63], v[208:211]
    v_mfma_f32_16x16x32_bf16 v[212:215], v[48:51], v[64:67], v[212:215]
    s_waitcnt lgkmcnt(5)
    s_add_u32 m0, s13, 12288
    s_nop 0
    buffer_load_dwordx4 v20, s[84:87], s88 offen offset:0 lds
    v_mfma_f32_16x16x32_bf16 v[216:219], v[48:51], v[68:71], v[216:219]
    buffer_load_dwordx4 v21, s[84:87], s88 offen offset:1024 lds
    s_waitcnt vmcnt(12)
    ds_read_b64_tr_b16 a[64:65], v46 offset:0
    ds_read_b64_tr_b16 a[66:67], v46 offset:512
    ds_read_b64_tr_b16 a[68:69], v47 offset:0
    ds_read_b64_tr_b16 a[70:71], v47 offset:512
    v_mfma_f32_16x16x32_bf16 v[220:223], v[48:51], v[80:83], v[220:223]
    ds_read2_b64 v[48:51], v27 offset0:168 offset1:169
    s_waitcnt lgkmcnt(15)
    v_mfma_f32_16x16x32_bf16 v[204:207], v[52:55], v[96:99], v[204:207]
    s_waitcnt lgkmcnt(5)
    buffer_load_dwordx4 v22, s[84:87], s88 offen offset:2048 lds
    buffer_load_dwordx4 v23, s[84:87], s88 offen offset:3072 lds
    s_add_u32 s88, s88, 131072
    s_cmp_eq_u32 s88, s89
    s_cselect_b32 s88, s90, s88
    v_mfma_f32_16x16x32_bf16 v[208:211], v[52:55], v[104:107], v[208:211]
    v_mfma_f32_16x16x32_bf16 v[212:215], v[52:55], v[8:11], v[212:215]
    s_waitcnt vmcnt(12)
    ds_read_b64_tr_b16 a[72:73], v46 offset:2048
    ds_read_b64_tr_b16 a[74:75], v46 offset:2560
    ds_read_b64_tr_b16 a[76:77], v47 offset:2048
    ds_read_b64_tr_b16 a[78:79], v47 offset:2560
    v_mfma_f32_16x16x32_bf16 v[216:219], v[52:55], v[28:31], v[216:219]
    s_waitcnt lgkmcnt(5)
    s_add_u32 m0, s13, 0
    s_nop 0
    buffer_load_dwordx4 v20, s[84:87], s88 offen offset:0 lds
    v_mfma_f32_16x16x32_bf16 v[220:223], v[52:55], v[32:35], v[220:223]
    buffer_load_dwordx4 v21, s[84:87], s88 offen offset:1024 lds
    ds_read2_b64 v[52:55], v27 offset0:136 offset1:137
    s_waitcnt lgkmcnt(15)
    v_mfma_f32_16x16x32_bf16 v[208:211], v[12:15], v[56:59], v[208:211]
    s_waitcnt vmcnt(12)
    ds_read_b64_tr_b16 a[80:81], v46 offset:4096
    ds_read_b64_tr_b16 a[82:83], v46 offset:4608
    ds_read_b64_tr_b16 a[84:85], v47 offset:4096
    ds_read_b64_tr_b16 a[86:87], v47 offset:4608
    v_mfma_f32_16x16x32_bf16 v[212:215], v[12:15], v[60:63], v[212:215]
    s_waitcnt lgkmcnt(5)
    buffer_load_dwordx4 v22, s[84:87], s88 offen offset:2048 lds
    v_mfma_f32_16x16x32_bf16 v[216:219], v[12:15], v[64:67], v[216:219]
    buffer_load_dwordx4 v23, s[84:87], s88 offen offset:3072 lds
    s_add_u32 s88, s88, 131072
    v_mfma_f32_16x16x32_bf16 v[220:223], v[12:15], v[68:71], v[220:223]
    s_waitcnt vmcnt(12)
    ds_read_b64_tr_b16 a[88:89], v46 offset:6144
    ds_read_b64_tr_b16 a[90:91], v46 offset:6656
    ds_read_b64_tr_b16 a[92:93], v47 offset:6144
    ds_read_b64_tr_b16 a[94:95], v47 offset:6656
    ds_read2_b64 v[12:15], v27 offset0:104 offset1:105
    s_waitcnt lgkmcnt(15)
    v_mfma_f32_16x16x32_bf16 v[208:211], v[40:43], v[96:99], v[208:211]
    s_waitcnt lgkmcnt(5)
    s_add_u32 m0, s13, 4096
    s_nop 0
    buffer_load_dwordx4 v20, s[84:87], s88 offen offset:0 lds
    v_mfma_f32_16x16x32_bf16 v[212:215], v[40:43], v[104:107], v[212:215]
    buffer_load_dwordx4 v21, s[84:87], s88 offen offset:1024 lds
    v_mfma_f32_16x16x32_bf16 v[216:219], v[40:43], v[8:11], v[216:219]
    s_waitcnt vmcnt(12)
    ds_read_b64_tr_b16 a[96:97], v46 offset:8192
    ds_read_b64_tr_b16 a[98:99], v46 offset:8704
    ds_read_b64_tr_b16 a[100:101], v47 offset:8192
    ds_read_b64_tr_b16 a[102:103], v47 offset:8704
    v_mfma_f32_16x16x32_bf16 v[220:223], v[40:43], v[28:31], v[220:223]
    s_waitcnt lgkmcnt(5)
    buffer_load_dwordx4 v22, s[84:87], s88 offen offset:2048 lds
    ds_read2_b64 v[40:43], v27 offset0:72 offset1:73
    s_waitcnt lgkmcnt(15)
    v_mfma_f32_16x16x32_bf16 v[212:215], v[48:51], v[56:59], v[212:215]
    buffer_load_dwordx4 v23, s[84:87], s88 offen offset:3072 lds
    s_add_u32 s88, s88, 131072
    s_cmp_eq_u32 s88, s89
    s_cselect_b32 s88, s90, s88
    v_mfma_f32_16x16x32_bf16 v[216:219], v[48:51], v[60:63], v[216:219]
    s_waitcnt vmcnt(12)
    ds_read_b64_tr_b16 a[104:105], v46 offset:10240
    ds_read_b64_tr_b16 a[106:107], v46 offset:10752
    ds_read_b64_tr_b16 a[108:109], v47 offset:10240
    ds_read_b64_tr_b16 a[110:111], v47 offset:10752
    v_mfma_f32_16x16x32_bf16 v[220:223], v[48:51], v[64:67], v[220:223]
    ds_read2_b64 v[48:51], v27 offset0:40 offset1:41
    s_waitcnt lgkmcnt(15)
    v_mfma_f32_16x16x32_bf16 v[212:215], v[52:55], v[96:99], v[212:215]
    s_waitcnt lgkmcnt(6)
    s_add_u32 m0, s13, 8192
    s_nop 0
    buffer_load_dwordx4 v20, s[84:87], s88 offen offset:0 lds
    v_mfma_f32_16x16x32_bf16 v[216:219], v[52:55], v[104:107], v[216:219]
    buffer_load_dwordx4 v21, s[84:87], s88 offen offset:1024 lds
    ds_read_b64 v[240:241], v114 offset:0
    ds_read_b64 v[242:243], v114 offset:512
    ds_read_b64 v[244:245], v114 offset:1024
    ds_read_b64 v[246:247], v114 offset:1536
    v_mfma_f32_16x16x32_bf16 v[220:223], v[52:55], v[8:11], v[220:223]
    ds_read2_b64 v[52:55], v27 offset0:8 offset1:9
    s_waitcnt lgkmcnt(15)
    v_mfma_f32_16x16x32_bf16 v[216:219], v[12:15], v[56:59], v[216:219]
    s_waitcnt vmcnt(12)
    ds_read_b64_tr_b16 a[112:113], v46 offset:12288
    ds_read_b64_tr_b16 a[114:115], v46 offset:12800
    ds_read_b64_tr_b16 a[116:117], v47 offset:12288
    ds_read_b64_tr_b16 a[118:119], v47 offset:12800
    v_mfma_f32_16x16x32_bf16 v[220:223], v[12:15], v[60:63], v[220:223]
    s_waitcnt lgkmcnt(10)
    buffer_load_dwordx4 v22, s[84:87], s88 offen offset:2048 lds
    ds_read2_b64 v[12:15], v36 offset0:224 offset1:225
    s_waitcnt lgkmcnt(15)
    v_mfma_f32_16x16x32_bf16 v[216:219], v[40:43], v[96:99], v[216:219]
    buffer_load_dwordx4 v23, s[84:87], s88 offen offset:3072 lds
    s_add_u32 s88, s88, 131072
    v_mfma_f32_16x16x32_bf16 v[220:223], v[40:43], v[104:107], v[220:223]
    ds_read2_b64 v[40:43], v36 offset0:192 offset1:193
    s_waitcnt lgkmcnt(11)
    v_mfma_f32_16x16x32_bf16 v[220:223], v[48:51], v[56:59], v[220:223]
    s_waitcnt lgkmcnt(7)
    v_lshlrev_b32 v224, 16, v240
    v_and_b32 v225, s59, v240
    ds_read2_b64 v[48:51], v36 offset0:160 offset1:161
    s_waitcnt lgkmcnt(7)
    v_mfma_f32_16x16x32_bf16 v[220:223], v[52:55], v[96:99], v[220:223]
    v_lshlrev_b32 v226, 16, v241
    v_and_b32 v227, s59, v241
    v_lshlrev_b32 v228, 16, v242
    v_and_b32 v229, s59, v242
    ds_read2_b64 v[52:55], v36 offset0:128 offset1:129
    s_waitcnt lgkmcnt(3)
    v_mfma_f32_16x16x32_bf16 v[192:195], v[12:15], v[116:119], v[192:195]
    s_waitcnt vmcnt(12)
    ds_read_b64_tr_b16 a[120:121], v46 offset:14336
    ds_read_b64_tr_b16 a[122:123], v46 offset:14848
    ds_read_b64_tr_b16 a[124:125], v47 offset:14336
    ds_read_b64_tr_b16 a[126:127], v47 offset:14848
    v_mfma_f32_16x16x32_bf16 v[196:199], v[12:15], v[124:127], v[196:199]
    v_mfma_f32_16x16x32_bf16 v[200:203], v[12:15], v[128:131], v[200:203]
    s_waitcnt lgkmcnt(8)
    s_add_u32 m0, s13, 12288
    s_nop 0
    buffer_load_dwordx4 v20, s[84:87], s88 offen offset:0 lds
    v_mfma_f32_16x16x32_bf16 v[204:207], v[12:15], v[144:147], v[204:207]
    buffer_load_dwordx4 v21, s[84:87], s88 offen offset:1024 lds
    v_lshlrev_b32 v230, 16, v243
    v_and_b32 v231, s59, v243
    v_mfma_f32_16x16x32_bf16 v[208:211], v[12:15], v[92:95], v[208:211]
    v_lshlrev_b32 v232, 16, v244
    v_and_b32 v233, s59, v244
    v_lshlrev_b32 v234, 16, v245
    v_and_b32 v235, s59, v245
    v_mfma_f32_16x16x32_bf16 v[212:215], v[12:15], v[148:151], v[212:215]
    s_waitcnt vmcnt(12)
    ds_read_b64_tr_b16 a[128:129], v46 offset:0
    ds_read_b64_tr_b16 a[130:131], v46 offset:512
    ds_read_b64_tr_b16 a[132:133], v47 offset:0
    ds_read_b64_tr_b16 a[134:135], v47 offset:512
    v_mfma_f32_16x16x32_bf16 v[216:219], v[12:15], v[152:155], v[216:219]
    v_mfma_f32_16x16x32_bf16 v[220:223], v[12:15], v[156:159], v[220:223]
    s_waitcnt lgkmcnt(4)
    buffer_load_dwordx4 v22, s[84:87], s88 offen offset:2048 lds
    buffer_load_dwordx4 v23, s[84:87], s88 offen offset:3072 lds
    s_add_u32 s88, s88, 131072
    s_cmp_eq_u32 s88, s89
    s_cselect_b32 s88, s90, s88
    ds_read2_b64 v[12:15], v36 offset0:96 offset1:97
    s_waitcnt lgkmcnt(11)
    v_mfma_f32_16x16x32_bf16 v[192:195], v[40:43], v[108:111], v[192:195]
    v_mfma_f32_16x16x32_bf16 v[196:199], v[40:43], v[160:163], v[196:199]
    v_lshlrev_b32 v236, 16, v246
    v_and_b32 v237, s59, v246
    v_lshlrev_b32 v238, 16, v247
    v_and_b32 v239, s59, v247
    v_mfma_f32_16x16x32_bf16 v[200:203], v[40:43], v[164:167], v[200:203]
    v_mul_f32 v224, v224, v38
    v_mul_f32 v225, v225, v38
    v_mfma_f32_16x16x32_bf16 v[204:207], v[40:43], v[168:171], v[204:207]
    s_waitcnt vmcnt(12)
    ds_read_b64_tr_b16 a[136:137], v46 offset:2048
    ds_read_b64_tr_b16 a[138:139], v46 offset:2560
    ds_read_b64_tr_b16 a[140:141], v47 offset:2048
    ds_read_b64_tr_b16 a[142:143], v47 offset:2560
    v_mfma_f32_16x16x32_bf16 v[208:211], v[40:43], v[88:91], v[208:211]
    s_waitcnt lgkmcnt(5)
    s_add_u32 m0, s13, 0
    s_nop 0
    buffer_load_dwordx4 v20, s[84:87], s88 offen offset:0 lds
    v_mfma_f32_16x16x32_bf16 v[212:215], v[40:43], v[172:175], v[212:215]
    buffer_load_dwordx4 v21, s[84:87], s88 offen offset:1024 lds
    v_mfma_f32_16x16x32_bf16 v[216:219], v[40:43], v[176:179], v[216:219]
    v_mul_f32 v226, v226, v38
    v_mul_f32 v227, v227, v38
    v_mul_f32 v228, v228, v38
    v_mul_f32 v229, v229, v38
    v_mfma_f32_16x16x32_bf16 v[220:223], v[40:43], v[180:183], v[220:223]
    v_mul_f32 v230, v230, v38
    v_mul_f32 v231, v231, v38
    ds_read2_b64 v[40:43], v36 offset0:64 offset1:65
    s_waitcnt lgkmcnt(15)
    v_mfma_f32_16x16x32_bf16 v[196:199], v[48:51], v[116:119], v[196:199]
    s_waitcnt vmcnt(12)
    ds_read_b64_tr_b16 a[144:145], v46 offset:4096
    ds_read_b64_tr_b16 a[146:147], v46 offset:4608
    ds_read_b64_tr_b16 a[148:149], v47 offset:4096
    ds_read_b64_tr_b16 a[150:151], v47 offset:4608
    v_mfma_f32_16x16x32_bf16 v[200:203], v[48:51], v[124:127], v[200:203]
    s_waitcnt lgkmcnt(5)
    buffer_load_dwordx4 v22, s[84:87], s88 offen offset:2048 lds
    v_mfma_f32_16x16x32_bf16 v[204:207], v[48:51], v[128:131], v[204:207]
    buffer_load_dwordx4 v23, s[84:87], s88 offen offset:3072 lds
    s_add_u32 s88, s88, 131072
    v_mfma_f32_16x16x32_bf16 v[208:211], v[48:51], v[144:147], v[208:211]
    v_mul_f32 v232, v232, v38
    v_mul_f32 v233, v233, v38
    v_mul_f32 v234, v234, v38
    v_mul_f32 v235, v235, v38
    v_mfma_f32_16x16x32_bf16 v[212:215], v[48:51], v[92:95], v[212:215]
    v_mul_f32 v236, v236, v38
    v_mul_f32 v237, v237, v38
    v_mfma_f32_16x16x32_bf16 v[216:219], v[48:51], v[148:151], v[216:219]
    v_mul_f32 v238, v238, v38
    v_mul_f32 v239, v239, v38
    v_cvt_pk_bf16_f32 v240, v224, v225
    v_cvt_pk_bf16_f32 v241, v226, v227
    v_mfma_f32_16x16x32_bf16 v[220:223], v[48:51], v[152:155], v[220:223]
    s_waitcnt vmcnt(12)
    ds_read_b64_tr_b16 a[152:153], v46 offset:6144
    ds_read_b64_tr_b16 a[154:155], v46 offset:6656
    ds_read_b64_tr_b16 a[156:157], v47 offset:6144
    ds_read_b64_tr_b16 a[158:159], v47 offset:6656
    ds_read2_b64 v[48:51], v36 offset0:32 offset1:33
    s_waitcnt lgkmcnt(15)
    v_mfma_f32_16x16x32_bf16 v[196:199], v[52:55], v[108:111], v[196:199]
    global_load_dwordx2 v[8:9], v122, s[80:81] sc1
    v_mfma_f32_16x16x32_bf16 v[200:203], v[52:55], v[160:163], v[200:203]
    s_waitcnt lgkmcnt(5)
    s_add_u32 m0, s13, 4096
    s_nop 0
    buffer_load_dwordx4 v20, s[84:87], s88 offen offset:0 lds
    v_mfma_f32_16x16x32_bf16 v[204:207], v[52:55], v[164:167], v[204:207]
    buffer_load_dwordx4 v21, s[84:87], s88 offen offset:1024 lds
    v_cvt_pk_bf16_f32 v242, v228, v229
    v_cvt_pk_bf16_f32 v243, v230, v231
    v_mfma_f32_16x16x32_bf16 v[208:211], v[52:55], v[168:171], v[208:211]
    v_cvt_pk_bf16_f32 v244, v232, v233
    v_cvt_pk_bf16_f32 v245, v234, v235
    v_cvt_pk_bf16_f32 v246, v236, v237
    v_cvt_pk_bf16_f32 v247, v238, v239
    v_mfma_f32_16x16x32_bf16 v[212:215], v[52:55], v[88:91], v[212:215]
    s_waitcnt vmcnt(13)
    ds_read_b64_tr_b16 a[160:161], v46 offset:8192
    ds_read_b64_tr_b16 a[162:163], v46 offset:8704
    ds_read_b64_tr_b16 a[164:165], v47 offset:8192
    ds_read_b64_tr_b16 a[166:167], v47 offset:8704
    v_mfma_f32_16x16x32_bf16 v[216:219], v[52:55], v[172:175], v[216:219]
    v_mfma_f32_16x16x32_bf16 v[220:223], v[52:55], v[176:179], v[220:223]
    s_waitcnt lgkmcnt(5)
    buffer_load_dwordx4 v22, s[84:87], s88 offen offset:2048 lds
    buffer_load_dwordx4 v23, s[84:87], s88 offen offset:3072 lds
    ds_read2_b64 v[52:55], v36 offset0:0 offset1:1
    s_waitcnt lgkmcnt(15)
    v_mfma_f32_16x16x32_bf16 v[200:203], v[12:15], v[116:119], v[200:203]
    v_lshlrev_b32 v224, 16, v240
    v_and_b32 v225, s59, v240
    v_lshlrev_b32 v226, 16, v241
    v_and_b32 v227, s59, v241
    v_mfma_f32_16x16x32_bf16 v[204:207], v[12:15], v[124:127], v[204:207]
    v_lshlrev_b32 v228, 16, v242
    v_and_b32 v229, s59, v242
    v_mfma_f32_16x16x32_bf16 v[208:211], v[12:15], v[128:131], v[208:211]
    v_lshlrev_b32 v230, 16, v243
    v_and_b32 v231, s59, v243
    v_lshlrev_b32 v232, 16, v244
    v_and_b32 v233, s59, v244
    v_mfma_f32_16x16x32_bf16 v[212:215], v[12:15], v[144:147], v[212:215]
    s_waitcnt vmcnt(13)
    ds_read_b64_tr_b16 a[168:169], v46 offset:10240
    ds_read_b64_tr_b16 a[170:171], v46 offset:10752
    ds_read_b64_tr_b16 a[172:173], v47 offset:10240
    ds_read_b64_tr_b16 a[174:175], v47 offset:10752
    v_mfma_f32_16x16x32_bf16 v[216:219], v[12:15], v[92:95], v[216:219]
    v_mfma_f32_16x16x32_bf16 v[220:223], v[12:15], v[148:151], v[220:223]
    v_lshlrev_b32 v234, 16, v245
    v_and_b32 v235, s59, v245
    v_lshlrev_b32 v236, 16, v246
    v_and_b32 v237, s59, v246
    global_load_dwordx2 v[24:25], v122, s[80:81] sc1
    ds_read2_b64 v[12:15], v27 offset0:224 offset1:225
    s_waitcnt lgkmcnt(15)
    v_mfma_f32_16x16x32_bf16 v[200:203], v[40:43], v[108:111], v[200:203]
    v_lshlrev_b32 v238, 16, v247
    v_and_b32 v239, s59, v247
    v_mfma_f32_16x16x32_bf16 v[204:207], v[40:43], v[160:163], v[204:207]
    v_mfma_f32_16x16x32_bf16 v[208:211], v[40:43], v[164:167], v[208:211]
    s_waitcnt vmcnt(12)
    ds_read_b64_tr_b16 a[176:177], v46 offset:12288
    ds_read_b64_tr_b16 a[178:179], v46 offset:12800
    ds_read_b64_tr_b16 a[180:181], v47 offset:12288
    ds_read_b64_tr_b16 a[182:183], v47 offset:12800
    v_mfma_f32_16x16x32_bf16 v[212:215], v[40:43], v[168:171], v[212:215]
    v_mfma_f32_16x16x32_bf16 v[216:219], v[40:43], v[88:91], v[216:219]
    v_mfma_f32_16x16x32_bf16 v[220:223], v[40:43], v[172:175], v[220:223]
    ds_read2_b64 v[40:43], v27 offset0:192 offset1:193
    s_waitcnt lgkmcnt(15)
    v_mfma_f32_16x16x32_bf16 v[204:207], v[48:51], v[116:119], v[204:207]
    v_mfma_f32_16x16x32_bf16 v[208:211], v[48:51], v[124:127], v[208:211]
    v_mfma_f32_16x16x32_bf16 v[212:215], v[48:51], v[128:131], v[212:215]
    s_waitcnt vmcnt(10)
    ds_read_b64_tr_b16 a[184:185], v46 offset:14336
    ds_read_b64_tr_b16 a[186:187], v46 offset:14848
    ds_read_b64_tr_b16 a[188:189], v47 offset:14336
    ds_read_b64_tr_b16 a[190:191], v47 offset:14848
    v_mfma_f32_16x16x32_bf16 v[216:219], v[48:51], v[144:147], v[216:219]
    v_mfma_f32_16x16x32_bf16 v[220:223], v[48:51], v[92:95], v[220:223]
    ds_read2_b64 v[48:51], v27 offset0:160 offset1:161
    s_waitcnt lgkmcnt(15)
    v_mfma_f32_16x16x32_bf16 v[204:207], v[52:55], v[108:111], v[204:207]
    v_mfma_f32_16x16x32_bf16 v[208:211], v[52:55], v[160:163], v[208:211]
    v_mfma_f32_16x16x32_bf16 v[212:215], v[52:55], v[164:167], v[212:215]
    s_waitcnt vmcnt(8)
    ds_read_b64_tr_b16 a[192:193], v46 offset:0
    ds_read_b64_tr_b16 a[194:195], v46 offset:512
    ds_read_b64_tr_b16 a[196:197], v47 offset:0
    ds_read_b64_tr_b16 a[198:199], v47 offset:512
    v_mfma_f32_16x16x32_bf16 v[216:219], v[52:55], v[168:171], v[216:219]
    v_mfma_f32_16x16x32_bf16 v[220:223], v[52:55], v[88:91], v[220:223]
    ds_read2_b64 v[52:55], v27 offset0:128 offset1:129
    s_waitcnt lgkmcnt(15)
    v_mfma_f32_16x16x32_bf16 v[208:211], v[12:15], v[116:119], v[208:211]
    s_waitcnt vmcnt(5)
    v_subrev_u32 v8, s100, v8
    v_cmp_ne_u32 s[26:27], s101, v9
    v_subrev_u32 v8, 2, v8
    v_cmp_lt_u32 vcc, 1, v8
    s_nop 1
    s_or_b64 s[26:27], s[26:27], vcc
    s_cbranch_scc0 L_poll4_ok
    s_waitcnt vmcnt(0)
    v_subrev_u32 v24, s100, v24
    v_cmp_ne_u32 s[26:27], s101, v25
    v_subrev_u32 v24, 2, v24
    v_cmp_lt_u32 vcc, 1, v24
    s_nop 1
    s_or_b64 s[26:27], s[26:27], vcc
    s_cbranch_scc0 L_poll4_ok
    s_mov_b32 s28, 0
L_poll4:
    global_load_dwordx2 v[24:25], v122, s[80:81] sc1
    s_add_u32 s28, s28, 1
    s_cmp_ge_u32 s28, 0x8000
    s_cbranch_scc1 L_poll4_ok
    s_waitcnt vmcnt(0)
    v_subrev_u32 v24, s100, v24
    v_cmp_ne_u32 s[26:27], s101, v25
    v_subrev_u32 v24, 2, v24
    v_cmp_lt_u32 vcc, 1, v24
    s_nop 1
    s_or_b64 s[26:27], s[26:27], vcc
    s_cbranch_scc1 L_poll4
L_poll4_ok:
    s_lshl_b32 s23, s18, 18
    s_mul_i32 s26, s12, 57344
    s_add_u32 s23, s23, s26
    s_add_u32 s23, s23, 4194304
    s_mov_b32 s93, s23
    s_add_u32 s92, s23, 57344
    s_lshl_b32 s26, s95, 13
    s_add_u32 s23, s23, s26
    s_mov_b32 s91, s23
    v_mfma_f32_16x16x32_bf16 v[212:215], v[12:15], v[124:127], v[212:215]
    buffer_load_dwordx4 v[8:11], v2, s[8:11], s23 offen offset:0
    v_mfma_f32_16x16x32_bf16 v[216:219], v[12:15], v[128:131], v[216:219]
    buffer_load_dwordx4 v[28:31], v2, s[8:11], s23 offen offset:2048
    s_add_u32 s23, s23, 4096
    s_waitcnt vmcnt(8)
    ds_read_b64_tr_b16 a[200:201], v46 offset:2048
    ds_read_b64_tr_b16 a[202:203], v46 offset:2560
    ds_read_b64_tr_b16 a[204:205], v47 offset:2048
    ds_read_b64_tr_b16 a[206:207], v47 offset:2560
    v_mfma_f32_16x16x32_bf16 v[220:223], v[12:15], v[144:147], v[220:223]
    buffer_load_dwordx4 v[32:35], v2, s[8:11], s23 offen offset:0
    ds_read2_b64 v[12:15], v27 offset0:96 offset1:97
    s_waitcnt lgkmcnt(15)
    v_mfma_f32_16x16x32_bf16 v[208:211], v[40:43], v[108:111], v[208:211]
    buffer_load_dwordx4 v[56:59], v2, s[8:11], s23 offen offset:2048
    s_add_u32 s23, s23, 4096
    s_cmp_eq_u32 s23, s92
    s_cselect_b32 s23, s93, s23
    v_mfma_f32_16x16x32_bf16 v[212:215], v[40:43], v[160:163], v[212:215]
    buffer_load_dwordx4 v[60:63], v2, s[8:11], s23 offen offset:0
    v_mfma_f32_16x16x32_bf16 v[216:219], v[40:43], v[164:167], v[216:219]
    buffer_load_dwordx4 v[64:67], v2, s[8:11], s23 offen offset:2048
    s_add_u32 s23, s23, 4096
    v_mfma_f32_16x16x32_bf16 v[220:223], v[40:43], v[168:171], v[220:223]
    buffer_load_dwordx4 v[68:71], v2, s[8:11], s23 offen offset:0
    s_waitcnt vmcnt(10)
    ds_read_b64_tr_b16 a[208:209], v46 offset:4096
    ds_read_b64_tr_b16 a[210:211], v46 offset:4608
    ds_read_b64_tr_b16 a[212:213], v47 offset:4096
    ds_read_b64_tr_b16 a[214:215], v47 offset:4608
    ds_read2_b64 v[40:43], v27 offset0:64 offset1:65
    s_waitcnt lgkmcnt(15)
    v_mfma_f32_16x16x32_bf16 v[212:215], v[48:51], v[116:119], v[212:215]
    buffer_load_dwordx4 v[72:75], v2, s[8:11], s23 offen offset:2048
    s_add_u32 s23, s23, 4096
    s_cmp_eq_u32 s23, s92
    s_cselect_b32 s23, s93, s23
    v_mfma_f32_16x16x32_bf16 v[216:219], v[48:51], v[124:127], v[216:219]
    v_mfma_f32_16x16x32_bf16 v[220:223], v[48:51], v[128:131], v[220:223]
    buffer_load_dwordx4 v[76:79], v2, s[8:11], s23 offen offset:0
    ds_read2_b64 v[48:51], v27 offset0:32 offset1:33
    s_waitcnt lgkmcnt(11)
    v_mfma_f32_16x16x32_bf16 v[212:215], v[52:55], v[108:111], v[212:215]
    v_mfma_f32_16x16x32_bf16 v[216:219], v[52:55], v[160:163], v[216:219]
    v_mfma_f32_16x16x32_bf16 v[220:223], v[52:55], v[164:167], v[220:223]
    buffer_load_dwordx4 v[80:83], v2, s[8:11], s23 offen offset:2048
    s_add_u32 s23, s23, 4096
    s_waitcnt vmcnt(11)
    ds_read_b64_tr_b16 a[216:217], v46 offset:6144
    ds_read_b64_tr_b16 a[218:219], v46 offset:6656
    ds_read_b64_tr_b16 a[220:221], v47 offset:6144
    ds_read_b64_tr_b16 a[222:223], v47 offset:6656
    ds_read2_b64 v[52:55], v27 offset0:0 offset1:1
    s_waitcnt lgkmcnt(11)
    v_mfma_f32_16x16x32_bf16 v[216:219], v[12:15], v[116:119], v[216:219]
    v_mfma_f32_16x16x32_bf16 v[220:223], v[12:15], v[124:127], v[220:223]
    s_waitcnt lgkmcnt(6)
    v_mfma_f32_16x16x32_bf16 v[216:219], v[40:43], v[108:111], v[216:219]
    buffer_load_dwordx4 v[84:87], v2, s[8:11], s23 offen offset:0
    v_mfma_f32_16x16x32_bf16 v[220:223], v[40:43], v[160:163], v[220:223]
    s_waitcnt lgkmcnt(5)
    v_mfma_f32_16x16x32_bf16 v[220:223], v[48:51], v[116:119], v[220:223]
    s_waitcnt lgkmcnt(0)
    v_mfma_f32_16x16x32_bf16 v[220:223], v[52:55], v[108:111], v[220:223]
    buffer_load_dwordx4 v[88:91], v2, s[8:11], s23 offen offset:2048
    s_add_u32 s23, s23, 4096
    s_cmp_eq_u32 s23, s92
    s_cselect_b32 s23, s93, s23
    s_cmp_eq_u32 s20, 1
    s_cbranch_scc1 L_cx5_1
    s_nop 7
    ds_write_b128 v112, v[208:211] offset:0
    ds_write_b128 v112, v[212:215] offset:1024
    ds_write_b128 v112, v[216:219] offset:2048
    ds_write_b128 v112, v[220:223] offset:3072
    s_branch L_cx5_j
L_cx5_1:
    s_nop 7
    ds_write_b128 v112, v[192:195] offset:0
    ds_write_b128 v112, v[196:199] offset:1024
    ds_write_b128 v112, v[200:203] offset:2048
    ds_write_b128 v112, v[204:207] offset:3072
    v_pk_mul_f32 v[192:193], v[208:209], s[44:45]
    v_pk_mul_f32 v[194:195], v[210:211], s[44:45]
    v_pk_mul_f32 v[196:197], v[212:213], s[44:45]
    v_pk_mul_f32 v[198:199], v[214:215], s[44:45]
    v_pk_mul_f32 v[200:201], v[216:217], s[44:45]
    v_pk_mul_f32 v[202:203], v[218:219], s[44:45]
    v_pk_mul_f32 v[204:205], v[220:221], s[44:45]
    v_pk_mul_f32 v[206:207], v[222:223], s[44:45]
L_cx5_j:
    s_waitcnt lgkmcnt(0)
    s_barrier
    ds_read_b128 v[208:211], v113 offset:0
    ds_read_b128 v[212:215], v113 offset:1024
    ds_read_b128 v[216:219], v113 offset:2048
    ds_read_b128 v[220:223], v113 offset:3072
    s_waitcnt lgkmcnt(0)
    v_pk_add_f32 v[192:193], v[192:193], v[208:209]
    v_pk_add_f32 v[194:195], v[194:195], v[210:211]
    v_pk_add_f32 v[196:197], v[196:197], v[212:213]
    v_pk_add_f32 v[198:199], v[198:199], v[214:215]
    v_pk_add_f32 v[200:201], v[200:201], v[216:217]
    v_pk_add_f32 v[202:203], v[202:203], v[218:219]
    v_pk_add_f32 v[204:205], v[204:205], v[220:221]
    v_pk_add_f32 v[206:207], v[206:207], v[222:223]
    v_cvt_pk_bf16_f32 v48, v192, v193
    v_cvt_pk_bf16_f32 v49, v194, v195
    v_cvt_pk_bf16_f32 v50, v196, v197
    v_cvt_pk_bf16_f32 v51, v198, v199
    v_cvt_pk_bf16_f32 v52, v200, v201
    v_cvt_pk_bf16_f32 v53, v202, v203
    v_cvt_pk_bf16_f32 v54, v204, v205
    v_cvt_pk_bf16_f32 v55, v206, v207
    v_lshlrev_b32 v192, 16, v48
    v_and_b32 v193, s59, v48
    v_lshlrev_b32 v194, 16, v49
    v_and_b32 v195, s59, v49
    v_lshlrev_b32 v196, 16, v50
    v_and_b32 v197, s59, v50
    v_lshlrev_b32 v198, 16, v51
    v_and_b32 v199, s59, v51
    v_lshlrev_b32 v200, 16, v52
    v_and_b32 v201, s59, v52
    v_lshlrev_b32 v202, 16, v53
    v_and_b32 v203, s59, v53
    v_lshlrev_b32 v204, 16, v54
    v_and_b32 v205, s59, v54
    v_lshlrev_b32 v206, 16, v55
    v_and_b32 v207, s59, v55
    buffer_load_dwordx4 v[12:15], v2, s[8:11], s23 offen offset:0
    v_pk_add_f32 v[192:193], v[192:193], v[224:225]
    v_pk_add_f32 v[194:195], v[194:195], v[226:227]
    v_pk_add_f32 v[196:197], v[196:197], v[228:229]
    v_pk_add_f32 v[198:199], v[198:199], v[230:231]
    v_pk_add_f32 v[200:201], v[200:201], v[232:233]
    v_pk_add_f32 v[202:203], v[202:203], v[234:235]
    v_pk_add_f32 v[204:205], v[204:205], v[236:237]
    v_pk_add_f32 v[206:207], v[206:207], v[238:239]
    v_cvt_pk_bf16_f32 v48, v192, v193
    v_cvt_pk_bf16_f32 v49, v194, v195
    v_cvt_pk_bf16_f32 v50, v196, v197
    v_cvt_pk_bf16_f32 v51, v198, v199
    v_cvt_pk_bf16_f32 v52, v200, v201
    v_cvt_pk_bf16_f32 v53, v202, v203
    v_cvt_pk_bf16_f32 v54, v204, v205
    v_cvt_pk_bf16_f32 v55, v206, v207
    global_store_dwordx2 v115, v[48:49], s[80:81] offset:0 sc1
    global_store_dwordx2 v115, v[50:51], s[80:81] offset:512 sc1
    global_store_dwordx2 v115, v[52:53], s[80:81] offset:1024 sc1
    global_store_dwordx2 v115, v[54:55], s[80:81] offset:1536 sc1
    s_waitcnt vmcnt(16) lgkmcnt(15)
    v_mfma_f32_32x32x16_bf16 v[192:207], v[8:11], a[0:3], 0
    buffer_load_dwordx4 v[236:239], v2, s[8:11], s23 offen offset:2048
    s_add_u32 s23, s23, 4096
    v_mfma_f32_32x32x16_bf16 v[208:223], v[8:11], a[4:7], 0
    buffer_load_dwordx4 v[232:235], v2, s[8:11], s23 offen offset:0
    s_waitcnt vmcnt(17) lgkmcnt(15)
    v_mfma_f32_32x32x16_bf16 v[192:207], v[28:31], a[8:11], v[192:207]
    buffer_load_dwordx4 v[228:231], v2, s[8:11], s23 offen offset:2048
    s_add_u32 s23, s23, 4096
    s_cmp_eq_u32 s23, s92
    s_cselect_b32 s23, s93, s23
    v_mfma_f32_32x32x16_bf16 v[208:223], v[28:31], a[12:15], v[208:223]
    buffer_load_dwordx4 v[224:227], v2, s[8:11], s23 offen offset:0
    s_waitcnt vmcnt(18) lgkmcnt(15)
    v_mfma_f32_32x32x16_bf16 v[192:207], v[32:35], a[16:19], v[192:207]
    buffer_load_dwordx4 v[28:31], v2, s[8:11], s23 offen offset:2048
    s_add_u32 s23, s23, 4096
    v_mfma_f32_32x32x16_bf16 v[208:223], v[32:35], a[20:23], v[208:223]
    buffer_load_dwordx4 v[32:35], v2, s[8:11], s23 offen offset:0
    s_waitcnt vmcnt(19) lgkmcnt(15)
    v_mfma_f32_32x32x16_bf16 v[192:207], v[56:59], a[24:27], v[192:207]
    buffer_load_dwordx4 v[8:11], v2, s[8:11], s23 offen offset:2048
    s_add_u32 s23, s23, 4096
    s_cmp_eq_u32 s23, s92
    s_cselect_b32 s23, s93, s23
    v_mfma_f32_32x32x16_bf16 v[208:223], v[56:59], a[28:31], v[208:223]
    buffer_load_dwordx4 v[56:59], v2, s[8:11], s23 offen offset:0
    s_waitcnt vmcnt(8)
    s_barrier
    s_cmp_lg_u32 s12, 0
    s_cbranch_scc1 L_fl6
    s_lshl_b32 s26, s14, 3
    s_add_u32 s26, s26, 12582912
    v_mov_b32 v26, s26
    s_or_b32 s26, s100, 3
    v_mov_b32 v38, s26
    v_mov_b32 v39, s101
    s_mov_b64 exec, 1
    global_store_dwordx2 v26, v[38:39], s[80:81] sc1
    s_mov_b64 exec, -1
L_fl6:
    s_waitcnt vmcnt(20) lgkmcnt(15)
    v_mfma_f32_32x32x16_bf16 v[192:207], v[60:63], a[32:35], v[192:207]
    buffer_load_dwordx4 v[40:43], v2, s[8:11], s23 offen offset:2048
    s_add_u32 s23, s23, 4096
    v_mfma_f32_32x32x16_bf16 v[208:223], v[60:63], a[36:39], v[208:223]
    buffer_load_dwordx4 v[60:63], v2, s[8:11], s23 offen offset:0
    s_waitcnt vmcnt(21) lgkmcnt(15)
    v_mfma_f32_32x32x16_bf16 v[192:207], v[64:67], a[40:43], v[192:207]
    v_mfma_f32_32x32x16_bf16 v[208:223], v[64:67], a[44:47], v[208:223]
    buffer_load_dwordx4 v[64:67], v2, s[8:11], s23 offen offset:2048
    s_add_u32 s23, s23, 4096
    s_cmp_eq_u32 s23, s92
    s_cselect_b32 s23, s93, s23
    s_waitcnt vmcnt(21) lgkmcnt(15)
    v_mfma_f32_32x32x16_bf16 v[192:207], v[68:71], a[48:51], v[192:207]
    v_mfma_f32_32x32x16_bf16 v[208:223], v[68:71], a[52:55], v[208:223]
    buffer_load_dwordx4 v[68:71], v2, s[8:11], s23 offen offset:0
    s_waitcnt vmcnt(21) lgkmcnt(15)
    v_mfma_f32_32x32x16_bf16 v[192:207], v[72:75], a[56:59], v[192:207]
    v_mfma_f32_32x32x16_bf16 v[208:223], v[72:75], a[60:63], v[208:223]
    buffer_load_dwordx4 v[72:75], v2, s[8:11], s23 offen offset:2048
    s_add_u32 s23, s23, 4096
    s_waitcnt vmcnt(21) lgkmcnt(15)
    v_mfma_f32_32x32x16_bf16 v[192:207], v[76:79], a[64:67], v[192:207]
    v_mfma_f32_32x32x16_bf16 v[208:223], v[76:79], a[68:71], v[208:223]
    buffer_load_dwordx4 v[76:79], v2, s[8:11], s23 offen offset:0
    s_waitcnt vmcnt(21) lgkmcnt(15)
    v_mfma_f32_32x32x16_bf16 v[192:207], v[80:83], a[72:75], v[192:207]
    v_mfma_f32_32x32x16_bf16 v[208:223], v[80:83], a[76:79], v[208:223]
    buffer_load_dwordx4 v[80:83], v2, s[8:11], s23 offen offset:2048
    s_waitcnt vmcnt(21) lgkmcnt(15)
    v_mfma_f32_32x32x16_bf16 v[192:207], v[84:87], a[80:83], v[192:207]
    v_mfma_f32_32x32x16_bf16 v[208:223], v[84:87], a[84:87], v[208:223]
    buffer_load_dwordx4 v[84:87], v2, s[8:11], s91 offen offset:512
    s_waitcnt vmcnt(21) lgkmcnt(15)
    v_mfma_f32_32x32x16_bf16 v[192:207], v[88:91], a[88:91], v[192:207]
    v_mfma_f32_32x32x16_bf16 v[208:223], v[88:91], a[92:95], v[208:223]
    buffer_load_dwordx4 v[88:91], v2, s[8:11], s91 offen offset:2560
    s_add_u32 s91, s91, 4096
    s_waitcnt vmcnt(21) lgkmcnt(15)
    v_mfma_f32_32x32x16_bf16 v[192:207], v[12:15], a[96:99], v[192:207]
    v_mfma_f32_32x32x16_bf16 v[208:223], v[12:15], a[100:103], v[208:223]
    buffer_load_dwordx4 v[12:15], v2, s[8:11], s91 offen offset:512
    s_waitcnt vmcnt(17) lgkmcnt(15)
    v_mfma_f32_32x32x16_bf16 v[192:207], v[236:239], a[104:107], v[192:207]
    v_mfma_f32_32x32x16_bf16 v[208:223], v[236:239], a[108:111], v[208:223]
    s_waitcnt vmcnt(16) lgkmcnt(15)
    v_mfma_f32_32x32x16_bf16 v[192:207], v[232:235], a[112:115], v[192:207]
    v_mfma_f32_32x32x16_bf16 v[208:223], v[232:235], a[116:119], v[208:223]
    s_waitcnt vmcnt(15) lgkmcnt(15)
    v_mfma_f32_32x32x16_bf16 v[192:207], v[228:231], a[120:123], v[192:207]
    v_mfma_f32_32x32x16_bf16 v[208:223], v[228:231], a[124:127], v[208:223]
    s_waitcnt vmcnt(14) lgkmcnt(15)
    v_mfma_f32_32x32x16_bf16 v[192:207], v[224:227], a[128:131], v[192:207]
    v_mfma_f32_32x32x16_bf16 v[208:223], v[224:227], a[132:135], v[208:223]
    s_waitcnt vmcnt(13) lgkmcnt(15)
    v_mfma_f32_32x32x16_bf16 v[192:207], v[28:31], a[136:139], v[192:207]
    v_mfma_f32_32x32x16_bf16 v[208:223], v[28:31], a[140:143], v[208:223]
    buffer_load_dwordx4 v[28:31], v2, s[8:11], s91 offen offset:2560
    s_add_u32 s91, s91, 4096
    s_cmp_eq_u32 s91, s92
    s_cselect_b32 s91, s93, s91
    s_waitcnt vmcnt(13) lgkmcnt(15)
    v_mfma_f32_32x32x16_bf16 v[192:207], v[32:35], a[144:147], v[192:207]
    v_mfma_f32_32x32x16_bf16 v[208:223], v[32:35], a[148:151], v[208:223]
    buffer_load_dwordx4 v[32:35], v2, s[8:11], s91 offen offset:512
    s_waitcnt vmcnt(13) lgkmcnt(15)
    v_mfma_f32_32x32x16_bf16 v[192:207], v[8:11], a[152:155], v[192:207]
    v_mfma_f32_32x32x16_bf16 v[208:223], v[8:11], a[156:159], v[208:223]
    buffer_load_dwordx4 v[8:11], v2, s[8:11], s91 offen offset:2560
    s_add_u32 s91, s91, 4096
    s_waitcnt vmcnt(13) lgkmcnt(15)
    v_mfma_f32_32x32x16_bf16 v[192:207], v[56:59], a[160:163], v[192:207]
    v_mfma_f32_32x32x16_bf16 v[208:223], v[56:59], a[164:167], v[208:223]
    buffer_load_dwordx4 v[56:59], v2, s[8:11], s91 offen offset:512
    s_waitcnt vmcnt(13) lgkmcnt(15)
    v_mfma_f32_32x32x16_bf16 v[192:207], v[40:43], a[168:171], v[192:207]
    v_mfma_f32_32x32x16_bf16 v[208:223], v[40:43], a[172:175], v[208:223]
    buffer_load_dwordx4 v[40:43], v2, s[8:11], s91 offen offset:2560
    s_add_u32 s91, s91, 4096
    s_cmp_eq_u32 s91, s92
    s_cselect_b32 s91, s93, s91
    s_waitcnt vmcnt(13) lgkmcnt(15)
    v_mfma_f32_32x32x16_bf16 v[192:207], v[60:63], a[176:179], v[192:207]
    v_mfma_f32_32x32x16_bf16 v[208:223], v[60:63], a[180:183], v[208:223]
    buffer_load_dwordx4 v[60:63], v2, s[8:11], s91 offen offset:512
    s_waitcnt vmcnt(13) lgkmcnt(15)
    v_mfma_f32_32x32x16_bf16 v[192:207], v[64:67], a[184:187], v[192:207]
    v_mfma_f32_32x32x16_bf16 v[208:223], v[64:67], a[188:191], v[208:223]
    buffer_load_dwordx4 v[64:67], v2, s[8:11], s91 offen offset:2560
    s_add_u32 s91, s91, 4096
    s_waitcnt vmcnt(13) lgkmcnt(15)
    v_mfma_f32_32x32x16_bf16 v[192:207], v[68:71], a[192:195], v[192:207]
    v_mfma_f32_32x32x16_bf16 v[208:223], v[68:71], a[196:199], v[208:223]
    buffer_load_dwordx4 v[68:71], v2, s[8:11], s91 offen offset:512
    s_waitcnt vmcnt(13) lgkmcnt(15)
    v_mfma_f32_32x32x16_bf16 v[192:207], v[72:75], a[200:203], v[192:207]
    v_mfma_f32_32x32x16_bf16 v[208:223], v[72:75], a[204:207], v[208:223]
    buffer_load_dwordx4 v[72:75], v2, s[8:11], s91 offen offset:2560
    s_add_u32 s91, s91, 4096
    s_cmp_eq_u32 s91, s92
    s_cselect_b32 s91, s93, s91
    s_waitcnt vmcnt(13) lgkmcnt(15)
    v_mfma_f32_32x32x16_bf16 v[192:207], v[76:79], a[208:211], v[192:207]
    v_mfma_f32_32x32x16_bf16 v[208:223], v[76:79], a[212:215], v[208:223]
    buffer_load_dwordx4 v[76:79], v2, s[8:11], s91 offen offset:512
    s_waitcnt vmcnt(13) lgkmcnt(9)
    v_mfma_f32_32x32x16_bf16 v[192:207], v[80:83], a[216:219], v[192:207]
    v_mfma_f32_32x32x16_bf16 v[208:223], v[80:83], a[220:223], v[208:223]
    buffer_load_dwordx4 v[80:83], v2, s[8:11], s91 offen offset:2560
    s_add_u32 s91, s91, 4096
    s_waitcnt vmcnt(13)
    v_mfma_f32_32x32x16_bf16 v[224:239], v[84:87], a[0:3], 0
    s_nop 6
    ds_write_b128 v100, v[192:195] offset:0
    v_mfma_f32_32x32x16_bf16 v[240:255], v[84:87], a[4:7], 0
    buffer_load_dwordx4 v[84:87], v2, s[8:11], s91 offen offset:512
    s_waitcnt vmcnt(13)
    v_mfma_f32_32x32x16_bf16 v[224:239], v[88:91], a[8:11], v[224:239]
    ds_write_b128 v101, v[196:199] offset:0
    v_mfma_f32_32x32x16_bf16 v[240:255], v[88:91], a[12:15], v[240:255]
    buffer_load_dwordx4 v[88:91], v2, s[8:11], s91 offen offset:2560
    s_add_u32 s91, s91, 4096
    s_cmp_eq_u32 s91, s92
    s_cselect_b32 s91, s93, s91
    s_waitcnt vmcnt(13)
    v_mfma_f32_32x32x16_bf16 v[224:239], v[12:15], a[16:19], v[224:239]
    ds_write_b128 v102, v[200:203] offset:0
    v_mfma_f32_32x32x16_bf16 v[240:255], v[12:15], a[20:23], v[240:255]
    buffer_load_dwordx4 v[12:15], v2, s[8:11], s91 offen offset:512
    s_waitcnt vmcnt(13)
    v_mfma_f32_32x32x16_bf16 v[224:239], v[28:31], a[24:27], v[224:239]
    ds_write_b128 v103, v[204:207] offset:0
    v_mfma_f32_32x32x16_bf16 v[240:255], v[28:31], a[28:31], v[240:255]
    buffer_load_dwordx4 v[28:31], v2, s[8:11], s91 offen offset:2560
    s_add_u32 s91, s91, 4096
    s_waitcnt vmcnt(13)
    v_mfma_f32_32x32x16_bf16 v[224:239], v[32:35], a[32:35], v[224:239]
    ds_write_b128 v100, v[208:211] offset:4096
    v_mfma_f32_32x32x16_bf16 v[240:255], v[32:35], a[36:39], v[240:255]
    buffer_load_dwordx4 v[32:35], v2, s[8:11], s91 offen offset:512
    s_waitcnt vmcnt(13)
    v_mfma_f32_32x32x16_bf16 v[224:239], v[8:11], a[40:43], v[224:239]
    ds_write_b128 v101, v[212:215] offset:4096
    v_mfma_f32_32x32x16_bf16 v[240:255], v[8:11], a[44:47], v[240:255]
    buffer_load_dwordx4 v[8:11], v2, s[8:11], s91 offen offset:2560
    s_add_u32 s91, s91, 4096
    s_cmp_eq_u32 s91, s92
    s_cselect_b32 s91, s93, s91
    s_waitcnt vmcnt(13)
    v_mfma_f32_32x32x16_bf16 v[224:239], v[56:59], a[48:51], v[224:239]
    ds_write_b128 v102, v[216:219] offset:4096
    v_mfma_f32_32x32x16_bf16 v[240:255], v[56:59], a[52:55], v[240:255]
    buffer_load_dwordx4 v[56:59], v2, s[8:11], s91 offen offset:512
    s_waitcnt vmcnt(13)
    v_mfma_f32_32x32x16_bf16 v[224:239], v[40:43], a[56:59], v[224:239]
    ds_write_b128 v103, v[220:223] offset:4096
    v_mfma_f32_32x32x16_bf16 v[240:255], v[40:43], a[60:63], v[240:255]
    buffer_load_dwordx4 v[40:43], v2, s[8:11], s91 offen offset:2560
    s_add_u32 s91, s91, 4096
    s_waitcnt vmcnt(13)
    v_mfma_f32_32x32x16_bf16 v[224:239], v[60:63], a[64:67], v[224:239]
    global_load_dwordx2 v[24:25], v123, s[80:81] sc1
    v_mfma_f32_32x32x16_bf16 v[240:255], v[60:63], a[68:71], v[240:255]
    buffer_load_dwordx4 v[60:63], v2, s[8:11], s91 offen offset:512
    s_waitcnt vmcnt(14)
    v_mfma_f32_32x32x16_bf16 v[224:239], v[64:67], a[72:75], v[224:239]
    v_mfma_f32_32x32x16_bf16 v[240:255], v[64:67], a[76:79], v[240:255]
    buffer_load_dwordx4 v[64:67], v2, s[8:11], s91 offen offset:2560
    s_add_u32 s91, s91, 4096
    s_cmp_eq_u32 s91, s92
    s_cselect_b32 s91, s93, s91
    s_waitcnt vmcnt(14)
    v_mfma_f32_32x32x16_bf16 v[224:239], v[68:71], a[80:83], v[224:239]
    s_waitcnt lgkmcnt(0)
    s_barrier
    ds_read_b128 v[192:195], v132 offset:0
    ds_read_b128 v[196:199], v133 offset:0
    ds_read_b128 v[200:203], v132 offset:40960
    ds_read_b128 v[204:207], v133 offset:40960
    v_mfma_f32_32x32x16_bf16 v[240:255], v[68:71], a[84:87], v[240:255]
    buffer_load_dwordx4 v[68:71], v2, s[8:11], s91 offen offset:512
    ds_read_b128 v[208:211], v134 offset:0
    ds_read_b128 v[212:215], v135 offset:0
    ds_read_b128 v[216:219], v134 offset:40960
    ds_read_b128 v[220:223], v135 offset:40960
    s_waitcnt vmcnt(14)
    v_mfma_f32_32x32x16_bf16 v[224:239], v[72:75], a[88:91], v[224:239]
    v_mfma_f32_32x32x16_bf16 v[240:255], v[72:75], a[92:95], v[240:255]
    buffer_load_dwordx4 v[72:75], v2, s[8:11], s91 offen offset:2560
    s_add_u32 s91, s91, 4096
    s_waitcnt vmcnt(14)
    v_mfma_f32_32x32x16_bf16 v[224:239], v[76:79], a[96:99], v[224:239]
    v_mfma_f32_32x32x16_bf16 v[240:255], v[76:79], a[100:103], v[240:255]
    buffer_load_dwordx4 v[76:79], v2, s[8:11], s91 offen offset:512
    s_waitcnt vmcnt(14)
    v_mfma_f32_32x32x16_bf16 v[224:239], v[80:83], a[104:107], v[224:239]
    v_mfma_f32_32x32x16_bf16 v[240:255], v[80:83], a[108:111], v[240:255]
    buffer_load_dwordx4 v[80:83], v2, s[8:11], s91 offen offset:2560
    s_waitcnt lgkmcnt(0)
    s_barrier
    v_add_f32 v192, v192, v200
    v_add_f32 v193, v193, v201
    v_add_f32 v208, v208, v216
    v_add_f32 v209, v209, v217
    v_add_f32 v194, v194, v202
    v_add_f32 v195, v195, v203
    v_add_f32 v210, v210, v218
    v_add_f32 v211, v211, v219
    s_waitcnt vmcnt(14)
    v_mfma_f32_32x32x16_bf16 v[224:239], v[84:87], a[112:115], v[224:239]
    v_mfma_f32_32x32x16_bf16 v[240:255], v[84:87], a[116:119], v[240:255]
    v_add_f32 v196, v196, v204
    v_add_f32 v197, v197, v205
    v_add_f32 v212, v212, v220
    v_add_f32 v213, v213, v221
    v_add_f32 v198, v198, v206
    v_add_f32 v199, v199, v207
    v_add_f32 v214, v214, v222
    v_add_f32 v215, v215, v223
    s_waitcnt vmcnt(13)
    v_mfma_f32_32x32x16_bf16 v[224:239], v[88:91], a[120:123], v[224:239]
    v_add_f32 v192, v192, v208
    v_add_f32 v193, v193, v209
    v_add_f32 v194, v194, v210
    v_add_f32 v195, v195, v211
    v_mfma_f32_32x32x16_bf16 v[240:255], v[88:91], a[124:127], v[240:255]
    v_add_f32 v196, v196, v212
    v_add_f32 v197, v197, v213
    v_add_f32 v198, v198, v214
    v_add_f32 v199, v199, v215
    s_waitcnt vmcnt(12)
    v_mfma_f32_32x32x16_bf16 v[224:239], v[12:15], a[128:131], v[224:239]
    v_cvt_pk_bf16_f32 v208, v192, v193
    v_cvt_pk_bf16_f32 v210, v194, v195
    v_cvt_pk_bf16_f32 v212, v196, v197
    v_cvt_pk_bf16_f32 v214, v198, v199
    v_lshlrev_b32 v192, 16, v208
    v_and_b32 v193, s59, v208
    v_lshlrev_b32 v194, 16, v210
    v_and_b32 v195, s59, v210
    v_mfma_f32_32x32x16_bf16 v[240:255], v[12:15], a[132:135], v[240:255]
    v_lshlrev_b32 v196, 16, v212
    v_and_b32 v197, s59, v212
    v_lshlrev_b32 v198, 16, v214
    v_and_b32 v199, s59, v214
    s_waitcnt vmcnt(11)
    v_mfma_f32_32x32x16_bf16 v[224:239], v[28:31], a[136:139], v[224:239]
    s_waitcnt vmcnt(6)
    v_subrev_u32 v24, s100, v24
    v_cmp_ne_u32 s[26:27], s101, v25
    v_subrev_u32 v24, 3, v24
    v_cmp_lt_u32 vcc, 0, v24
    s_nop 1
    s_or_b64 s[26:27], s[26:27], vcc
    s_cbranch_scc0 L_poll7_ok
    s_mov_b32 s28, 0
L_poll7:
    global_load_dwordx2 v[24:25], v123, s[80:81] sc1
    s_add_u32 s28, s28, 1
    s_cmp_ge_u32 s28, 0x8000
    s_cbranch_scc1 L_poll7_ok
    s_waitcnt vmcnt(0)
    v_subrev_u32 v24, s100, v24
    v_cmp_ne_u32 s[26:27], s101, v25
    v_subrev_u32 v24, 3, v24
    v_cmp_lt_u32 vcc, 0, v24
    s_nop 1
    s_or_b64 s[26:27], s[26:27], vcc
    s_cbranch_scc1 L_poll7
L_poll7_ok:
    s_add_u32 m0, s13, 26624
    s_nop 0
    buffer_load_dwordx4 v121, s[8:11], s30 offen lds
    s_add_u32 s30, s30, 0x20000
    s_add_u32 m0, s13, 27648
    s_nop 0
    buffer_load_dwordx4 v121, s[8:11], s30 offen lds
    v_mfma_f32_32x32x16_bf16 v[240:255], v[28:31], a[140:143], v[240:255]
    s_waitcnt vmcnt(12)
    v_mfma_f32_32x32x16_bf16 v[224:239], v[32:35], a[144:147], v[224:239]
    v_mfma_f32_32x32x16_bf16 v[240:255], v[32:35], a[148:151], v[240:255]
    s_waitcnt vmcnt(11)
    v_mfma_f32_32x32x16_bf16 v[224:239], v[8:11], a[152:155], v[224:239]
    v_add_f32 v192, v192, v44
    v_add_f32 v193, v193, v45
    v_add_f32 v194, v194, v44
    v_add_f32 v195, v195, v45
    v_mfma_f32_32x32x16_bf16 v[240:255], v[8:11], a[156:159], v[240:255]
    v_add_f32 v196, v196, v44
    v_add_f32 v197, v197, v45
    v_add_f32 v198, v198, v44
    v_add_f32 v199, v199, v45
    s_waitcnt vmcnt(10)
    v_mfma_f32_32x32x16_bf16 v[224:239], v[56:59], a[160:163], v[224:239]
    v_cvt_pk_bf16_f32 v208, v192, v193
    v_cvt_pk_bf16_f32 v210, v194, v195
    v_cvt_pk_bf16_f32 v212, v196, v197
    v_cvt_pk_bf16_f32 v214, v198, v199
    v_lshlrev_b32 v192, 16, v208
    v_and_b32 v193, s59, v208
    v_lshlrev_b32 v194, 16, v210
    v_and_b32 v195, s59, v210
    v_mfma_f32_32x32x16_bf16 v[240:255], v[56:59], a[164:167], v[240:255]
    v_lshlrev_b32 v196, 16, v212
    v_and_b32 v197, s59, v212
    v_lshlrev_b32 v198, 16, v214
    v_and_b32 v199, s59, v214
    s_waitcnt vmcnt(9)
    v_mfma_f32_32x32x16_bf16 v[224:239], v[40:43], a[168:171], v[224:239]
    v_mul_f32 v200, v192, s42
    v_mul_f32 v201, v193, s43
    v_mul_f32 v202, v194, s42
    v_mul_f32 v203, v195, s43
    v_mul_f32 v204, v196, s42
    v_mul_f32 v205, v197, s43
    v_mul_f32 v206, v198, s42
    v_mul_f32 v207, v199, s43
    s_waitcnt vmcnt(7)
    v_mfma_f32_32x32x16_bf16 v[224:239], v[60:63], a[176:179], v[224:239]
    v_exp_f32 v200, v200
    v_exp_f32 v201, v201
    s_waitcnt vmcnt(6)
    v_mfma_f32_32x32x16_bf16 v[224:239], v[64:67], a[184:187], v[224:239]
    v_exp_f32 v202, v202
    v_exp_f32 v203, v203
    v_exp_f32 v204, v204
    s_waitcnt vmcnt(5)
    v_mfma_f32_32x32x16_bf16 v[224:239], v[68:71], a[192:195], v[224:239]
    v_exp_f32 v205, v205
    v_exp_f32 v206, v206
    v_exp_f32 v207, v207
    s_waitcnt vmcnt(4)
    v_mfma_f32_32x32x16_bf16 v[224:239], v[72:75], a[200:203], v[224:239]
    v_add_f32 v200, v200, s44
    v_add_f32 v201, v201, s45
    v_add_f32 v202, v202, s44
    v_add_f32 v203, v203, s45
    v_add_f32 v204, v204, s44
    v_add_f32 v205, v205, s45
    v_add_f32 v206, v206, s44
    v_add_f32 v207, v207, s45
    s_waitcnt vmcnt(3)
    v_mfma_f32_32x32x16_bf16 v[224:239], v[76:79], a[208:211], v[224:239]
    v_rcp_f32 v200, v200
    v_rcp_f32 v201, v201
    s_waitcnt vmcnt(2)
    v_mfma_f32_32x32x16_bf16 v[224:239], v[80:83], a[216:219], v[224:239]
    v_rcp_f32 v202, v202
    v_rcp_f32 v203, v203
    v_rcp_f32 v204, v204
    v_mfma_f32_32x32x16_bf16 v[240:255], v[40:43], a[172:175], v[240:255]
    v_rcp_f32 v205, v205
    v_rcp_f32 v206, v206
    v_rcp_f32 v207, v207
    v_mfma_f32_32x32x16_bf16 v[240:255], v[60:63], a[180:183], v[240:255]
    s_nop 3
    ds_write_b128 v100, v[224:227]
    v_mul_f32 v192, v192, v200
    v_mul_f32 v193, v193, v201
    v_mul_f32 v194, v194, v202
    v_mul_f32 v195, v195, v203
    v_mfma_f32_32x32x16_bf16 v[240:255], v[64:67], a[188:191], v[240:255]
    ds_write_b128 v101, v[228:231]
    v_mul_f32 v196, v196, v204
    v_mul_f32 v197, v197, v205
    v_mul_f32 v198, v198, v206
    v_mul_f32 v199, v199, v207
    v_cvt_pk_bf16_f32 v208, v192, v193
    v_cvt_pk_bf16_f32 v209, v194, v195
    v_cvt_pk_bf16_f32 v210, v196, v197
    v_cvt_pk_bf16_f32 v211, v198, v199
    v_mfma_f32_32x32x16_bf16 v[240:255], v[68:71], a[196:199], v[240:255]
    ds_write_b128 v102, v[232:235]
    s_waitcnt vmcnt(0)
    ds_read_b64_tr_b16 v[48:49], v120 offset:0
    ds_read_b64_tr_b16 v[50:51], v120 offset:128
    v_mfma_f32_32x32x16_bf16 v[240:255], v[72:75], a[204:207], v[240:255]
    ds_write_b128 v103, v[236:239]
    v_mfma_f32_32x32x16_bf16 v[240:255], v[76:79], a[212:215], v[240:255]
    v_mfma_f32_32x32x16_bf16 v[240:255], v[80:83], a[220:223], v[240:255]
    s_waitcnt lgkmcnt(1)
    v_lshlrev_b32 v192, 16, v208
    v_and_b32 v193, s59, v208
    v_lshlrev_b32 v200, 16, v48
    v_and_b32 v201, s59, v48
    v_lshlrev_b32 v194, 16, v209
    v_and_b32 v195, s59, v209
    v_lshlrev_b32 v202, 16, v49
    v_and_b32 v203, s59, v49
    s_nop 2
    ds_write_b128 v100, v[240:243] offset:4096
    ds_write_b128 v101, v[244:247] offset:4096
    v_lshlrev_b32 v196, 16, v210
    v_and_b32 v197, s59, v210
    v_lshlrev_b32 v204, 16, v50
    v_and_b32 v205, s59, v50
    v_lshlrev_b32 v198, 16, v211
    v_and_b32 v199, s59, v211
    v_lshlrev_b32 v206, 16, v51
    v_and_b32 v207, s59, v51
    v_pk_mul_f32 v[192:193], v[192:193], v[200:201]
    v_pk_mul_f32 v[194:195], v[194:195], v[202:203]
    ds_write_b128 v102, v[248:251] offset:4096
    ds_write_b128 v103, v[252:255] offset:4096
    v_pk_mul_f32 v[196:197], v[196:197], v[204:205]
    v_pk_mul_f32 v[198:199], v[198:199], v[206:207]
    v_cvt_pk_bf16_f32 v208, v192, v193
    v_cvt_pk_bf16_f32 v209, v194, v195
    v_cvt_pk_bf16_f32 v210, v196, v197
    v_cvt_pk_bf16_f32 v211, v198, v199
    s_waitcnt vmcnt(63)
    v_lshlrev_b32 v192, 16, v208
    v_and_b32 v193, s59, v208
    v_lshlrev_b32 v200, 16, v136
    v_and_b32 v201, s59, v136
    s_waitcnt vmcnt(0) lgkmcnt(0)
    s_barrier
    ds_read_b128 v[224:227], v132 offset:0
    ds_read_b128 v[228:231], v133 offset:0
    ds_read_b128 v[232:235], v132 offset:40960
    ds_read_b128 v[236:239], v133 offset:40960
    v_lshlrev_b32 v194, 16, v209
    v_and_b32 v195, s59, v209
    v_lshlrev_b32 v202, 16, v137
    v_and_b32 v203, s59, v137
    v_lshlrev_b32 v196, 16, v210
    v_and_b32 v197, s59, v210
    v_lshlrev_b32 v204, 16, v138
    v_and_b32 v205, s59, v138
    v_lshlrev_b32 v198, 16, v211
    v_and_b32 v199, s59, v211
    v_lshlrev_b32 v206, 16, v139
    v_and_b32 v207, s59, v139
    ds_read_b128 v[240:243], v134 offset:0
    ds_read_b128 v[244:247], v135 offset:0
    ds_read_b128 v[248:251], v134 offset:40960
    ds_read_b128 v[252:255], v135 offset:40960
    v_pk_add_f32 v[192:193], v[192:193], v[200:201]
    v_pk_add_f32 v[194:195], v[194:195], v[202:203]
    v_pk_add_f32 v[196:197], v[196:197], v[204:205]
    v_pk_add_f32 v[198:199], v[198:199], v[206:207]
    v_cvt_pk_bf16_f32 v208, v192, v193
    v_cvt_pk_bf16_f32 v209, v194, v195
    v_cvt_pk_bf16_f32 v210, v196, v197
    v_cvt_pk_bf16_f32 v211, v198, v199
    global_store_dwordx4 v3, v[208:211], s[76:77] offset:0 sc1
    ds_read_b64_tr_b16 v[8:9], v120 offset:1024
    ds_read_b64_tr_b16 v[10:11], v120 offset:1152
    s_waitcnt lgkmcnt(0)
    s_waitcnt lgkmcnt(0)
    v_pk_add_f32 v[224:225], v[224:225], v[232:233]
    v_pk_add_f32 v[240:241], v[240:241], v[248:249]
    v_pk_add_f32 v[226:227], v[226:227], v[234:235]
    v_pk_add_f32 v[242:243], v[242:243], v[250:251]
    v_pk_add_f32 v[228:229], v[228:229], v[236:237]
    v_pk_add_f32 v[244:245], v[244:245], v[252:253]
    v_pk_add_f32 v[230:231], v[230:231], v[238:239]
    v_pk_add_f32 v[246:247], v[246:247], v[254:255]
    v_pk_add_f32 v[224:225], v[224:225], v[240:241]
    v_pk_add_f32 v[226:227], v[226:227], v[242:243]
    v_pk_add_f32 v[228:229], v[228:229], v[244:245]
    v_pk_add_f32 v[230:231], v[230:231], v[246:247]
    v_cvt_pk_bf16_f32 v240, v224, v225
    v_cvt_pk_bf16_f32 v242, v226, v227
    v_cvt_pk_bf16_f32 v244, v228, v229
    v_cvt_pk_bf16_f32 v246, v230, v231
    v_lshlrev_b32 v224, 16, v240
    v_and_b32 v225, s59, v240
    v_lshlrev_b32 v226, 16, v242
    v_and_b32 v227, s59, v242
    v_lshlrev_b32 v228, 16, v244
    v_and_b32 v229, s59, v244
    v_lshlrev_b32 v230, 16, v246
    v_and_b32 v231, s59, v246
    v_pk_add_f32 v[224:225], v[224:225], v[44:45]
    v_pk_add_f32 v[226:227], v[226:227], v[44:45]
    v_pk_add_f32 v[228:229], v[228:229], v[44:45]
    v_pk_add_f32 v[230:231], v[230:231], v[44:45]
    v_cvt_pk_bf16_f32 v240, v224, v225
    v_cvt_pk_bf16_f32 v242, v226, v227
    v_cvt_pk_bf16_f32 v244, v228, v229
    v_cvt_pk_bf16_f32 v246, v230, v231
    v_lshlrev_b32 v224, 16, v240
    v_and_b32 v225, s59, v240
    v_lshlrev_b32 v226, 16, v242
    v_and_b32 v227, s59, v242
    v_lshlrev_b32 v228, 16, v244
    v_and_b32 v229, s59, v244
    v_lshlrev_b32 v230, 16, v246
    v_and_b32 v231, s59, v246
    v_pk_mul_f32 v[232:233], v[224:225], s[42:43]
    v_pk_mul_f32 v[234:235], v[226:227], s[42:43]
    v_pk_mul_f32 v[236:237], v[228:229], s[42:43]
    v_pk_mul_f32 v[238:239], v[230:231], s[42:43]
    v_exp_f32 v232, v232
    v_exp_f32 v233, v233
    v_exp_f32 v234, v234
    v_exp_f32 v235, v235
    v_exp_f32 v236, v236
    v_exp_f32 v237, v237
    v_exp_f32 v238, v238
    v_exp_f32 v239, v239
    v_pk_add_f32 v[232:233], v[232:233], s[44:45]
    v_pk_add_f32 v[234:235], v[234:235], s[44:45]
    v_pk_add_f32 v[236:237], v[236:237], s[44:45]
    v_pk_add_f32 v[238:239], v[238:239], s[44:45]
    v_rcp_f32 v232, v232
    v_rcp_f32 v233, v233
    v_rcp_f32 v234, v234
    v_rcp_f32 v235, v235
    v_rcp_f32 v236, v236
    v_rcp_f32 v237, v237
    v_rcp_f32 v238, v238
    v_rcp_f32 v239, v239
    v_pk_mul_f32 v[224:225], v[224:225], v[232:233]
    v_pk_mul_f32 v[226:227], v[226:227], v[234:235]
    v_pk_mul_f32 v[228:229], v[228:229], v[236:237]
    v_pk_mul_f32 v[230:231], v[230:231], v[238:239]
    v_cvt_pk_bf16_f32 v240, v224, v225
    v_cvt_pk_bf16_f32 v241, v226, v227
    v_cvt_pk_bf16_f32 v242, v228, v229
    v_cvt_pk_bf16_f32 v243, v230, v231
    v_lshlrev_b32 v224, 16, v240
    v_and_b32 v225, s59, v240
    v_lshlrev_b32 v232, 16, v8
    v_and_b32 v233, s59, v8
    v_lshlrev_b32 v226, 16, v241
    v_and_b32 v227, s59, v241
    v_lshlrev_b32 v234, 16, v9
    v_and_b32 v235, s59, v9
    v_lshlrev_b32 v228, 16, v242
    v_and_b32 v229, s59, v242
    v_lshlrev_b32 v236, 16, v10
    v_and_b32 v237, s59, v10
    v_lshlrev_b32 v230, 16, v243
    v_and_b32 v231, s59, v243
    v_lshlrev_b32 v238, 16, v11
    v_and_b32 v239, s59, v11
    v_pk_mul_f32 v[224:225], v[224:225], v[232:233]
    v_pk_mul_f32 v[226:227], v[226:227], v[234:235]
    v_pk_mul_f32 v[228:229], v[228:229], v[236:237]
    v_pk_mul_f32 v[230:231], v[230:231], v[238:239]
    v_cvt_pk_bf16_f32 v240, v224, v225
    v_cvt_pk_bf16_f32 v241, v226, v227
    v_cvt_pk_bf16_f32 v242, v228, v229
    v_cvt_pk_bf16_f32 v243, v230, v231
    s_waitcnt vmcnt(63)
    v_lshlrev_b32 v224, 16, v240
    v_and_b32 v225, s59, v240
    v_lshlrev_b32 v232, 16, v140
    v_and_b32 v233, s59, v140
    v_lshlrev_b32 v226, 16, v241
    v_and_b32 v227, s59, v241
    v_lshlrev_b32 v234, 16, v141
    v_and_b32 v235, s59, v141
    v_lshlrev_b32 v228, 16, v242
    v_and_b32 v229, s59, v242
    v_lshlrev_b32 v236, 16, v142
    v_and_b32 v237, s59, v142
    v_lshlrev_b32 v230, 16, v243
    v_and_b32 v231, s59, v243
    v_lshlrev_b32 v238, 16, v143
    v_and_b32 v239, s59, v143
    v_pk_add_f32 v[224:225], v[224:225], v[232:233]
    v_pk_add_f32 v[226:227], v[226:227], v[234:235]
    v_pk_add_f32 v[228:229], v[228:229], v[236:237]
    v_pk_add_f32 v[230:231], v[230:231], v[238:239]
    v_cvt_pk_bf16_f32 v240, v224, v225
    v_cvt_pk_bf16_f32 v241, v226, v227
    v_cvt_pk_bf16_f32 v242, v228, v229
    v_cvt_pk_bf16_f32 v243, v230, v231
    global_store_dwordx4 v3, v[240:243], s[76:77] offset:64 sc1
L_done:
    s_endpgm
L_dummy:
    s_sub_u32 s26, s25, 28
    s_lshl_b32 s26, s26, 2
    s_add_u32 s26, s26, s12
    s_mov_b32 s30, s26
    s_lshr_b32 s26, s24, 1
    s_lshl_b32 s26, s26, 10
    v_lshlrev_b32 v9, 12, v1
    v_add_u32 v9, s26, v9
    s_waitcnt vmcnt(18)
    v_lshlrev_b32 v12, 16, v32
    v_mul_f32 v10, s32, v12
    v_lshlrev_b32 v26, 16, v26
    v_fma_f32 v13, v12, s32, -v10
    v_lshlrev_b32 v27, 16, v27
    v_fma_f32 v13, v12, s33, v13
    v_exp_f32 v10, v10
    v_mul_f32 v13, s34, v13
    v_lshlrev_b32 v28, 16, v28
    v_lshlrev_b32 v29, 16, v29
    v_fma_f32 v10, v10, v13, v10
    v_lshlrev_b32 v30, 16, v30
    v_lshlrev_b32 v31, 16, v31
    v_cvt_pk_bf16_f32 v10, v10, v10
    v_lshlrev_b32 v33, 16, v33
    v_lshlrev_b32 v34, 16, v34
    v_lshlrev_b32 v10, 16, v10
    v_lshlrev_b32 v35, 16, v35
    v_lshlrev_b32 v36, 16, v36
    v_mul_f32 v26, v10, v26
    v_mul_f32 v27, v10, v27
    v_mul_f32 v28, v10, v28
    v_mul_f32 v29, v10, v29
    v_mul_f32 v33, v10, v33
    v_mul_f32 v34, v10, v34
    v_mul_f32 v50, s32, v26
    v_mul_f32 v51, s35, v27
    v_mul_f32 v58, v31, v29
    v_mul_f32 v59, v31, v28
    v_mul_f32 v60, v36, v34
    v_mul_f32 v61, v36, v33
    v_fma_f32 v58, v30, v28, -v58
    v_fma_f32 v59, v30, v29, v59
    v_fma_f32 v60, v35, v33, -v60
    v_fma_f32 v61, v35, v34, v61
    v_mul_f32 v54, s56, v50
    v_mul_f32 v55, s56, v51
    v_mul_f32 v56, s57, v50
    v_mul_f32 v57, s57, v51
    v_max3_f32 v12, abs(v58), abs(v59), abs(v60)
    v_fract_f32 v51, v51
    v_max_f32 v12, v12, abs(v61)
    v_exp_f32 v50, v50
    v_fract_f32 v55, v55
    v_max_f32_dpp v12, v12, v12 quad_perm:[1,0,3,2] row_mask:0xf bank_mask:0xf
    v_cos_f32 v62, v51
    v_fract_f32 v57, v57
    v_max_f32_dpp v12, v12, v12 quad_perm:[2,3,0,1] row_mask:0xf bank_mask:0xf
    v_sin_f32 v63, v51
    v_exp_f32 v54, v54
    v_max_f32_dpp v12, v12, v12 row_half_mirror row_mask:0xf bank_mask:0xf
    v_cos_f32 v88, v55
    v_pk_mul_f32 v[62:63], v[62:63], v[50:51] op_sel_hi:[1,0]
    v_max_f32_dpp v12, v12, v12 row_mirror row_mask:0xf bank_mask:0xf
    v_sin_f32 v89, v55
    v_mov_b32 v13, v12
    v_exp_f32 v56, v56
    s_nop 0
    v_permlane16_swap_b32 v12, v13
    v_cos_f32 v90, v57
    v_pk_mul_f32 v[88:89], v[88:89], v[54:55] op_sel_hi:[1,0]
    v_max_f32 v12, v12, v13
    v_sin_f32 v91, v57
    v_mov_b32 v13, v12
    v_pk_mul_f32 v[92:93], v[62:63], v[62:63] op_sel_hi:[1,0]
    s_waitcnt vmcnt(0)
    v_cmp_eq_u32 vcc, 0, v25
    s_cbranch_vccz L_zp2_ok
    s_mov_b32 s26, 0
L_zp2:
    global_load_dwordx2 v[24:25], v52, s[78:79] sc1
    s_add_u32 s26, s26, 1
    s_cmp_ge_u32 s26, 0x8000
    s_cbranch_scc1 L_zp2_ok
    s_waitcnt vmcnt(0)
    v_cmp_eq_u32 vcc, 0, v25
    s_cbranch_vccnz L_zp2
L_zp2_ok:
    v_readfirstlane_b32 s100, v24
    v_readfirstlane_b32 s101, v25
    s_barrier
    s_cmp_lg_u32 s12, 0
    s_cbranch_scc1 L_fl8
    s_lshl_b32 s26, s14, 3
    s_add_u32 s26, s26, 12582912
    v_mov_b32 v11, s26
    s_or_b32 s26, s100, 1
    v_mov_b32 v94, s26
    v_mov_b32 v95, s101
    s_mov_b64 exec, 1
    global_store_dwordx2 v11, v[94:95], s[80:81] sc1
    s_mov_b64 exec, -1
L_fl8:
    v_permlane32_swap_b32 v12, v13
    v_pk_mul_f32 v[90:91], v[90:91], v[56:57] op_sel_hi:[1,0]
    v_pk_fma_f32 v[92:93], v[62:63], v[62:63], v[92:93] op_sel:[1,1,0] op_sel_hi:[0,1,1] neg_lo:[1,0,0]
    v_max_f32 v12, v12, v13
    v_mov_b32 v11, 0x3c00
    v_and_b32 v12, 0x7f800000, v12
    v_max_u32 v12, 0x00800000, v12
    v_min_u32 v48, 0x7e800000, v12
    v_sub_u32 v13, 0x7f000000, v48
    v_pk_mul_f32 v[58:59], v[58:59], v[12:13] op_sel:[0,1] neg_hi:[0,1]
    v_pk_mul_f32 v[26:27], v[88:89], v[88:89] op_sel_hi:[1,0]
    v_pk_mul_f32 v[28:29], v[90:91], v[90:91] op_sel_hi:[1,0]
    v_pk_mul_f32 v[30:31], v[92:93], v[62:63] op_sel_hi:[1,0]
    v_pk_mul_f32 v[32:33], v[92:93], v[92:93] op_sel_hi:[1,0]
    v_pk_mul_f32 v[34:35], v[58:59], v[88:89] op_sel_hi:[1,0]
    v_pk_mul_f32 v[50:51], v[58:59], v[90:91] op_sel_hi:[1,0]
    v_cvt_pk_f16_f32 v10, v62, v63
    v_cvt_pk_f16_f32 v36, v92, v93
    v_cvt_pk_f16_f32 v52, v58, v59
    v_pk_fma_f32 v[26:27], v[88:89], v[88:89], v[26:27] op_sel:[1,1,0] op_sel_hi:[0,1,1] neg_lo:[1,0,0]
    v_pk_fma_f32 v[28:29], v[90:91], v[90:91], v[28:29] op_sel:[1,1,0] op_sel_hi:[0,1,1] neg_lo:[1,0,0]
    v_pk_fma_f32 v[30:31], v[92:93], v[62:63], v[30:31] op_sel:[1,1,0] op_sel_hi:[0,1,1] neg_lo:[1,0,0]
    v_pk_fma_f32 v[32:33], v[92:93], v[92:93], v[32:33] op_sel:[1,1,0] op_sel_hi:[0,1,1] neg_lo:[1,0,0]
    v_pk_fma_f32 v[34:35], v[58:59], v[88:89], v[34:35] op_sel:[1,1,0] op_sel_hi:[0,1,1] neg_hi:[1,0,0]
    v_pk_fma_f32 v[50:51], v[58:59], v[90:91], v[50:51] op_sel:[1,1,0] op_sel_hi:[0,1,1] neg_hi:[1,0,0]
    v_pk_mul_f32 v[54:55], v[26:27], v[26:27] op_sel_hi:[1,0]
    v_pk_mul_f32 v[56:57], v[28:29], v[28:29] op_sel_hi:[1,0]
    v_pk_mul_f32 v[60:61], v[58:59], v[26:27] op_sel_hi:[1,0]
    v_pk_mul_f32 v[94:95], v[34:35], v[26:27] op_sel_hi:[1,0]
    v_pk_mul_f32 v[96:97], v[34:35], v[90:91] op_sel_hi:[1,0]
    v_pk_mul_f32 v[98:99], v[32:33], v[62:63] op_sel_hi:[1,0]
    v_pk_mul_f32 v[100:101], v[32:33], v[92:93] op_sel_hi:[1,0]
    v_pk_mul_f32 v[102:103], v[32:33], v[30:31] op_sel_hi:[1,0]
    v_pk_mul_f32 v[104:105], v[28:29], v[92:93] op_sel_hi:[1,0]
    v_pk_mul_f32 v[106:107], v[28:29], v[32:33] op_sel_hi:[1,0]
    v_cvt_pk_f16_f32 v53, v50, v51
    v_cvt_pk_f16_f32 v108, v28, v29
    v_cvt_pk_f16_f32 v109, v30, v31
    v_cvt_pk_f16_f32 v110, v32, v33
    v_cvt_pk_f16_f32 v111, v34, v35
    v_pk_fma_f32 v[54:55], v[26:27], v[26:27], v[54:55] op_sel:[1,1,0] op_sel_hi:[0,1,1] neg_lo:[1,0,0]
    v_pk_fma_f32 v[56:57], v[28:29], v[28:29], v[56:57] op_sel:[1,1,0] op_sel_hi:[0,1,1] neg_lo:[1,0,0]
    v_pk_fma_f32 v[60:61], v[58:59], v[26:27], v[60:61] op_sel:[1,1,0] op_sel_hi:[0,1,1] neg_hi:[1,0,0]
    v_pk_fma_f32 v[94:95], v[34:35], v[26:27], v[94:95] op_sel:[1,1,0] op_sel_hi:[0,1,1] neg_hi:[1,0,0]
    v_pk_fma_f32 v[96:97], v[34:35], v[90:91], v[96:97] op_sel:[1,1,0] op_sel_hi:[0,1,1] neg_hi:[1,0,0]
    v_pk_fma_f32 v[98:99], v[32:33], v[62:63], v[98:99] op_sel:[1,1,0] op_sel_hi:[0,1,1] neg_lo:[1,0,0]
    v_pk_fma_f32 v[100:101], v[32:33], v[92:93], v[100:101] op_sel:[1,1,0] op_sel_hi:[0,1,1] neg_lo:[1,0,0]
    v_pk_fma_f32 v[102:103], v[32:33], v[30:31], v[102:103] op_sel:[1,1,0] op_sel_hi:[0,1,1] neg_lo:[1,0,0]
    v_pk_fma_f32 v[104:105], v[28:29], v[92:93], v[104:105] op_sel:[1,1,0] op_sel_hi:[0,1,1] neg_lo:[1,0,0]
    v_pk_fma_f32 v[106:107], v[28:29], v[32:33], v[106:107] op_sel:[1,1,0] op_sel_hi:[0,1,1] neg_lo:[1,0,0]
    ds_write2st64_b32 v64, v53, v52 offset0:16 offset1:0
    v_pk_mul_f32 v[52:53], v[58:59], v[54:55] op_sel_hi:[1,0]
    v_pk_mul_f32 v[112:113], v[34:35], v[54:55] op_sel_hi:[1,0]
    v_pk_mul_f32 v[114:115], v[60:61], v[54:55] op_sel_hi:[1,0]
    v_pk_mul_f32 v[116:117], v[94:95], v[54:55] op_sel_hi:[1,0]
    v_pk_mul_f32 v[118:119], v[60:61], v[90:91] op_sel_hi:[1,0]
    v_pk_mul_f32 v[120:121], v[94:95], v[90:91] op_sel_hi:[1,0]
    v_pk_mul_f32 v[122:123], v[56:57], v[28:29] op_sel_hi:[1,0]
    v_pk_mul_f32 v[124:125], v[56:57], v[56:57] op_sel_hi:[1,0]
    v_pk_mul_f32 v[126:127], v[56:57], v[32:33] op_sel_hi:[1,0]
    v_pk_mul_f32 v[128:129], v[28:29], v[100:101] op_sel_hi:[1,0]
    v_cvt_pk_f16_f32 v130, v56, v57
    v_cvt_pk_f16_f32 v131, v96, v97
    v_cvt_pk_f16_f32 v132, v104, v105
    v_cvt_pk_f16_f32 v133, v106, v107
    v_cvt_pk_f16_f32 v134, v60, v61
    v_cvt_pk_f16_f32 v135, v94, v95
    v_cvt_pk_f16_f32 v136, v98, v99
    v_cvt_pk_f16_f32 v137, v100, v101
    v_cvt_pk_f16_f32 v138, v102, v103
    v_pk_fma_f32 v[52:53], v[58:59], v[54:55], v[52:53] op_sel:[1,1,0] op_sel_hi:[0,1,1] neg_hi:[1,0,0]
    v_pk_fma_f32 v[112:113], v[34:35], v[54:55], v[112:113] op_sel:[1,1,0] op_sel_hi:[0,1,1] neg_hi:[1,0,0]
    v_pk_fma_f32 v[114:115], v[60:61], v[54:55], v[114:115] op_sel:[1,1,0] op_sel_hi:[0,1,1] neg_hi:[1,0,0]
    v_pk_fma_f32 v[116:117], v[94:95], v[54:55], v[116:117] op_sel:[1,1,0] op_sel_hi:[0,1,1] neg_hi:[1,0,0]
    v_pk_fma_f32 v[118:119], v[60:61], v[90:91], v[118:119] op_sel:[1,1,0] op_sel_hi:[0,1,1] neg_hi:[1,0,0]
    v_pk_fma_f32 v[120:121], v[94:95], v[90:91], v[120:121] op_sel:[1,1,0] op_sel_hi:[0,1,1] neg_hi:[1,0,0]
    v_pk_fma_f32 v[122:123], v[56:57], v[28:29], v[122:123] op_sel:[1,1,0] op_sel_hi:[0,1,1] neg_lo:[1,0,0]
    v_pk_fma_f32 v[124:125], v[56:57], v[56:57], v[124:125] op_sel:[1,1,0] op_sel_hi:[0,1,1] neg_lo:[1,0,0]
    v_pk_fma_f32 v[126:127], v[56:57], v[32:33], v[126:127] op_sel:[1,1,0] op_sel_hi:[0,1,1] neg_lo:[1,0,0]
    v_pk_fma_f32 v[128:129], v[28:29], v[100:101], v[128:129] op_sel:[1,1,0] op_sel_hi:[0,1,1] neg_lo:[1,0,0]
    ds_write2st64_b32 v64, v130, v11 offset0:112 offset1:96
    ds_write2st64_b32 v65, v131, v111 offset0:17 offset1:1
    ds_write_b32 v73, v132 offset:26880
    ds_write_b32 v74, v133 offset:27136
    v_pk_mul_f32 v[130:131], v[52:53], v[54:55] op_sel_hi:[1,0]
    v_pk_mul_f32 v[132:133], v[112:113], v[54:55] op_sel_hi:[1,0]
    v_pk_mul_f32 v[140:141], v[114:115], v[54:55] op_sel_hi:[1,0]
    v_pk_mul_f32 v[142:143], v[116:117], v[54:55] op_sel_hi:[1,0]
    v_pk_mul_f32 v[144:145], v[52:53], v[90:91] op_sel_hi:[1,0]
    v_pk_mul_f32 v[146:147], v[112:113], v[90:91] op_sel_hi:[1,0]
    v_pk_mul_f32 v[148:149], v[114:115], v[90:91] op_sel_hi:[1,0]
    v_pk_mul_f32 v[150:151], v[116:117], v[90:91] op_sel_hi:[1,0]
    v_pk_mul_f32 v[152:153], v[122:123], v[32:33] op_sel_hi:[1,0]
    v_pk_mul_f32 v[154:155], v[124:125], v[28:29] op_sel_hi:[1,0]
    v_pk_mul_f32 v[156:157], v[124:125], v[56:57] op_sel_hi:[1,0]
    v_pk_mul_f32 v[158:159], v[124:125], v[122:123] op_sel_hi:[1,0]
    v_pk_mul_f32 v[160:161], v[124:125], v[124:125] op_sel_hi:[1,0]
    v_cvt_pk_f16_f32 v11, v118, v119
    v_cvt_pk_f16_f32 v111, v120, v121
    v_cvt_pk_f16_f32 v139, v122, v123
    v_cvt_pk_f16_f32 v162, v124, v125
    v_cvt_pk_f16_f32 v163, v126, v127
    v_cvt_pk_f16_f32 v164, v128, v129
    v_cvt_pk_f16_f32 v165, v52, v53
    v_cvt_pk_f16_f32 v166, v112, v113
    v_cvt_pk_f16_f32 v167, v114, v115
    v_cvt_pk_f16_f32 v168, v116, v117
    v_pk_fma_f32 v[130:131], v[52:53], v[54:55], v[130:131] op_sel:[1,1,0] op_sel_hi:[0,1,1] neg_hi:[1,0,0]
    v_pk_fma_f32 v[132:133], v[112:113], v[54:55], v[132:133] op_sel:[1,1,0] op_sel_hi:[0,1,1] neg_hi:[1,0,0]
    v_pk_fma_f32 v[140:141], v[114:115], v[54:55], v[140:141] op_sel:[1,1,0] op_sel_hi:[0,1,1] neg_hi:[1,0,0]
    v_pk_fma_f32 v[142:143], v[116:117], v[54:55], v[142:143] op_sel:[1,1,0] op_sel_hi:[0,1,1] neg_hi:[1,0,0]
    v_pk_fma_f32 v[144:145], v[52:53], v[90:91], v[144:145] op_sel:[1,1,0] op_sel_hi:[0,1,1] neg_hi:[1,0,0]
    v_pk_fma_f32 v[146:147], v[112:113], v[90:91], v[146:147] op_sel:[1,1,0] op_sel_hi:[0,1,1] neg_hi:[1,0,0]
    v_pk_fma_f32 v[148:149], v[114:115], v[90:91], v[148:149] op_sel:[1,1,0] op_sel_hi:[0,1,1] neg_hi:[1,0,0]
    v_pk_fma_f32 v[150:151], v[116:117], v[90:91], v[150:151] op_sel:[1,1,0] op_sel_hi:[0,1,1] neg_hi:[1,0,0]
    v_pk_fma_f32 v[152:153], v[122:123], v[32:33], v[152:153] op_sel:[1,1,0] op_sel_hi:[0,1,1] neg_lo:[1,0,0]
    v_pk_fma_f32 v[154:155], v[124:125], v[28:29], v[154:155] op_sel:[1,1,0] op_sel_hi:[0,1,1] neg_lo:[1,0,0]
    v_pk_fma_f32 v[156:157], v[124:125], v[56:57], v[156:157] op_sel:[1,1,0] op_sel_hi:[0,1,1] neg_lo:[1,0,0]
    v_pk_fma_f32 v[158:159], v[124:125], v[122:123], v[158:159] op_sel:[1,1,0] op_sel_hi:[0,1,1] neg_lo:[1,0,0]
    v_pk_fma_f32 v[160:161], v[124:125], v[124:125], v[160:161] op_sel:[1,1,0] op_sel_hi:[0,1,1] neg_lo:[1,0,0]
    ds_write2st64_b32 v66, v11, v134 offset0:18 offset1:2
    ds_write2st64_b32 v67, v111, v135 offset0:19 offset1:3
    ds_write2st64_b32 v66, v139, v36 offset0:114 offset1:98
    ds_write2st64_b32 v68, v162, v110 offset0:116 offset1:100
    ds_write2st64_b32 v65, v163, v10 offset0:113 offset1:97
    ds_write_b32 v75, v164 offset:27392
    v_pk_mul_f32 v[10:11], v[130:131], v[54:55] op_sel_hi:[1,0]
    v_pk_mul_f32 v[110:111], v[132:133], v[54:55] op_sel_hi:[1,0]
    v_pk_mul_f32 v[134:135], v[140:141], v[54:55] op_sel_hi:[1,0]
    v_pk_mul_f32 v[162:163], v[142:143], v[54:55] op_sel_hi:[1,0]
    v_pk_mul_f32 v[170:171], v[130:131], v[90:91] op_sel_hi:[1,0]
    v_pk_mul_f32 v[172:173], v[132:133], v[90:91] op_sel_hi:[1,0]
    v_pk_mul_f32 v[174:175], v[140:141], v[90:91] op_sel_hi:[1,0]
    v_pk_mul_f32 v[176:177], v[142:143], v[90:91] op_sel_hi:[1,0]
    v_cvt_pk_f16_f32 v36, v144, v145
    v_cvt_pk_f16_f32 v139, v146, v147
    v_cvt_pk_f16_f32 v164, v148, v149
    v_cvt_pk_f16_f32 v169, v150, v151
    v_cvt_pk_f16_f32 v178, v152, v153
    v_cvt_pk_f16_f32 v179, v154, v155
    v_cvt_pk_f16_f32 v180, v156, v157
    v_cvt_pk_f16_f32 v181, v158, v159
    v_cvt_pk_f16_f32 v182, v160, v161
    v_cvt_pk_f16_f32 v183, v130, v131
    v_cvt_pk_f16_f32 v184, v132, v133
    v_cvt_pk_f16_f32 v185, v140, v141
    v_cvt_pk_f16_f32 v186, v142, v143
    v_pk_fma_f32 v[10:11], v[130:131], v[54:55], v[10:11] op_sel:[1,1,0] op_sel_hi:[0,1,1] neg_hi:[1,0,0]
    v_pk_fma_f32 v[110:111], v[132:133], v[54:55], v[110:111] op_sel:[1,1,0] op_sel_hi:[0,1,1] neg_hi:[1,0,0]
    v_pk_fma_f32 v[134:135], v[140:141], v[54:55], v[134:135] op_sel:[1,1,0] op_sel_hi:[0,1,1] neg_hi:[1,0,0]
    v_pk_fma_f32 v[162:163], v[142:143], v[54:55], v[162:163] op_sel:[1,1,0] op_sel_hi:[0,1,1] neg_hi:[1,0,0]
    v_pk_fma_f32 v[170:171], v[130:131], v[90:91], v[170:171] op_sel:[1,1,0] op_sel_hi:[0,1,1] neg_hi:[1,0,0]
    v_pk_fma_f32 v[172:173], v[132:133], v[90:91], v[172:173] op_sel:[1,1,0] op_sel_hi:[0,1,1] neg_hi:[1,0,0]
    v_pk_fma_f32 v[174:175], v[140:141], v[90:91], v[174:175] op_sel:[1,1,0] op_sel_hi:[0,1,1] neg_hi:[1,0,0]
    v_pk_fma_f32 v[176:177], v[142:143], v[90:91], v[176:177] op_sel:[1,1,0] op_sel_hi:[0,1,1] neg_hi:[1,0,0]
    ds_write2st64_b32 v68, v36, v165 offset0:20 offset1:4
    ds_write2st64_b32 v69, v139, v166 offset0:21 offset1:5
    ds_write2st64_b32 v70, v164, v167 offset0:22 offset1:6
    ds_write2st64_b32 v71, v169, v168 offset0:23 offset1:7
    ds_write2st64_b32 v67, v178, v109 offset0:115 offset1:99
    ds_write2st64_b32 v69, v179, v136 offset0:117 offset1:101
    ds_write2st64_b32 v70, v180, v137 offset0:118 offset1:102
    ds_write2st64_b32 v71, v181, v138 offset0:119 offset1:103
    ds_write2st64_b32 v72, v182, v108 offset0:120 offset1:104
    v_pk_mul_f32 v[108:109], v[10:11], v[90:91] op_sel_hi:[1,0]
    v_pk_mul_f32 v[136:137], v[110:111], v[90:91] op_sel_hi:[1,0]
    v_pk_mul_f32 v[138:139], v[134:135], v[90:91] op_sel_hi:[1,0]
    v_pk_mul_f32 v[164:165], v[162:163], v[90:91] op_sel_hi:[1,0]
    v_cvt_pk_f16_f32 v36, v170, v171
    v_cvt_pk_f16_f32 v166, v172, v173
    v_cvt_pk_f16_f32 v167, v174, v175
    v_cvt_pk_f16_f32 v168, v176, v177
    v_cvt_pk_f16_f32 v169, v10, v11
    v_cvt_pk_f16_f32 v178, v110, v111
    v_cvt_pk_f16_f32 v179, v134, v135
    v_cvt_pk_f16_f32 v180, v162, v163
    v_pk_fma_f32 v[108:109], v[10:11], v[90:91], v[108:109] op_sel:[1,1,0] op_sel_hi:[0,1,1] neg_hi:[1,0,0]
    v_pk_fma_f32 v[136:137], v[110:111], v[90:91], v[136:137] op_sel:[1,1,0] op_sel_hi:[0,1,1] neg_hi:[1,0,0]
    v_pk_fma_f32 v[138:139], v[134:135], v[90:91], v[138:139] op_sel:[1,1,0] op_sel_hi:[0,1,1] neg_hi:[1,0,0]
    v_pk_fma_f32 v[164:165], v[162:163], v[90:91], v[164:165] op_sel:[1,1,0] op_sel_hi:[0,1,1] neg_hi:[1,0,0]
    ds_write2st64_b32 v72, v36, v183 offset0:24 offset1:8
    ds_write2st64_b32 v73, v166, v184 offset0:25 offset1:9
    ds_write2st64_b32 v74, v167, v185 offset0:26 offset1:10
    ds_write2st64_b32 v75, v168, v186 offset0:27 offset1:11
    v_cvt_pk_f16_f32 v36, v108, v109
    v_cvt_pk_f16_f32 v166, v136, v137
    v_cvt_pk_f16_f32 v167, v138, v139
    v_cvt_pk_f16_f32 v168, v164, v165
    ds_write2st64_b32 v76, v36, v169 offset0:28 offset1:12
    ds_write2st64_b32 v77, v166, v178 offset0:29 offset1:13
    ds_write2st64_b32 v78, v167, v179 offset0:30 offset1:14
    ds_write2st64_b32 v79, v168, v180 offset0:31 offset1:15
    s_waitcnt lgkmcnt(0)
    s_barrier
    s_add_u32 s26, s30, 0
    s_cmp_ge_u32 s26, 28
    s_cselect_b32 s27, 1, 0
    s_cmp_ge_u32 s26, 56
    s_cselect_b32 s27, 2, s27
    s_mul_i32 s28, s27, 28
    s_sub_u32 s26, s26, s28
    s_lshr_b32 s28, s26, 2
    s_cmp_ge_u32 s28, 3
    s_addc_u32 s28, s28, 0
    s_and_b32 s26, s26, 3
    s_mul_i32 s26, s26, 1835008
    s_lshl_b32 s27, s27, 1
    s_add_u32 s27, s27, s28
    s_add_u32 s27, s27, 1
    s_cmp_ge_u32 s27, 7
    s_cselect_b32 s29, 7, 0
    s_sub_u32 s27, s27, s29
    s_lshl_b32 s27, s27, 18
    s_add_u32 s26, s26, s27
    s_lshl_b32 s28, s28, 7
    s_add_u32 s26, s26, s28
    v_add_u32 v8, s26, v9
    global_load_dword v37, v8, s[72:73]
    s_add_u32 s26, s30, 16
    s_cmp_ge_u32 s26, 28
    s_cselect_b32 s27, 1, 0
    s_cmp_ge_u32 s26, 56
    s_cselect_b32 s27, 2, s27
    s_mul_i32 s28, s27, 28
    s_sub_u32 s26, s26, s28
    s_lshr_b32 s28, s26, 2
    s_cmp_ge_u32 s28, 3
    s_addc_u32 s28, s28, 0
    s_and_b32 s26, s26, 3
    s_mul_i32 s26, s26, 1835008
    s_lshl_b32 s27, s27, 1
    s_add_u32 s27, s27, s28
    s_add_u32 s27, s27, 1
    s_cmp_ge_u32 s27, 7
    s_cselect_b32 s29, 7, 0
    s_sub_u32 s27, s27, s29
    s_lshl_b32 s27, s27, 18
    s_add_u32 s26, s26, s27
    s_lshl_b32 s28, s28, 7
    s_add_u32 s26, s26, s28
    v_add_u32 v8, s26, v9
    global_load_dword v37, v8, s[72:73]
    s_add_u32 s26, s30, 32
    s_cmp_ge_u32 s26, 28
    s_cselect_b32 s27, 1, 0
    s_cmp_ge_u32 s26, 56
    s_cselect_b32 s27, 2, s27
    s_mul_i32 s28, s27, 28
    s_sub_u32 s26, s26, s28
    s_lshr_b32 s28, s26, 2
    s_cmp_ge_u32 s28, 3
    s_addc_u32 s28, s28, 0
    s_and_b32 s26, s26, 3
    s_mul_i32 s26, s26, 1835008
    s_lshl_b32 s27, s27, 1
    s_add_u32 s27, s27, s28
    s_add_u32 s27, s27, 1
    s_cmp_ge_u32 s27, 7
    s_cselect_b32 s29, 7, 0
    s_sub_u32 s27, s27, s29
    s_lshl_b32 s27, s27, 18
    s_add_u32 s26, s26, s27
    s_lshl_b32 s28, s28, 7
    s_add_u32 s26, s26, s28
    v_add_u32 v8, s26, v9
    global_load_dword v37, v8, s[72:73]
    s_add_u32 s26, s30, 48
    s_cmp_ge_u32 s26, 28
    s_cselect_b32 s27, 1, 0
    s_cmp_ge_u32 s26, 56
    s_cselect_b32 s27, 2, s27
    s_mul_i32 s28, s27, 28
    s_sub_u32 s26, s26, s28
    s_lshr_b32 s28, s26, 2
    s_cmp_ge_u32 s28, 3
    s_addc_u32 s28, s28, 0
    s_and_b32 s26, s26, 3
    s_mul_i32 s26, s26, 1835008
    s_lshl_b32 s27, s27, 1
    s_add_u32 s27, s27, s28
    s_add_u32 s27, s27, 1
    s_cmp_ge_u32 s27, 7
    s_cselect_b32 s29, 7, 0
    s_sub_u32 s27, s27, s29
    s_lshl_b32 s27, s27, 18
    s_add_u32 s26, s26, s27
    s_lshl_b32 s28, s28, 7
    s_add_u32 s26, s26, s28
    v_add_u32 v8, s26, v9
    global_load_dword v37, v8, s[72:73]
    s_add_u32 s26, s30, 64
    s_cmp_ge_u32 s26, 28
    s_cselect_b32 s27, 1, 0
    s_cmp_ge_u32 s26, 56
    s_cselect_b32 s27, 2, s27
    s_mul_i32 s28, s27, 28
    s_sub_u32 s26, s26, s28
    s_lshr_b32 s28, s26, 2
    s_cmp_ge_u32 s28, 3
    s_addc_u32 s28, s28, 0
    s_and_b32 s26, s26, 3
    s_mul_i32 s26, s26, 1835008
    s_lshl_b32 s27, s27, 1
    s_add_u32 s27, s27, s28
    s_add_u32 s27, s27, 1
    s_cmp_ge_u32 s27, 7
    s_cselect_b32 s29, 7, 0
    s_sub_u32 s27, s27, s29
    s_lshl_b32 s27, s27, 18
    s_add_u32 s26, s26, s27
    s_lshl_b32 s28, s28, 7
    s_add_u32 s26, s26, s28
    v_add_u32 v8, s26, v9
    global_load_dword v37, v8, s[72:73]
    s_lshr_b32 s26, s30, 2
    s_cmp_eq_u32 s12, 3
    s_cselect_b32 s27, 2, s12
    s_cselect_b32 s28, 7, 3
    s_mul_i32 s26, s26, 1835008
    s_lshl_b32 s27, s27, 1
    s_add_u32 s27, s27, s28
    s_add_u32 s27, s27, 1
    s_cmp_ge_u32 s27, 7
    s_cselect_b32 s29, 7, 0
    s_sub_u32 s27, s27, s29
    s_lshl_b32 s27, s27, 18
    s_add_u32 s26, s26, s27
    s_lshl_b32 s28, s28, 7
    s_add_u32 s26, s26, s28
    v_add_u32 v8, s26, v9
    global_load_dword v37, v8, s[72:73]
    s_lshl_b32 s26, s12, 9
    s_add_u32 s26, s26, 12582912
    v_lshl_add_u32 v10, v1, 3, s26
    ds_read_b128 v[52:55], v80 offset:0
    ds_read_b128 v[56:59], v84 offset:0
    ds_read_b128 v[60:63], v84 offset:4096
    ds_read_b128 v[64:67], v81 offset:0
    ds_read_b128 v[68:71], v85 offset:0
    ds_read_b128 v[72:75], v85 offset:4096
    ds_read_b128 v[88:91], v82 offset:0
    ds_read_b128 v[92:95], v86 offset:0
    ds_read_b128 v[96:99], v86 offset:4096
    ds_read_b128 v[100:103], v83 offset:0
    ds_read_b128 v[104:107], v87 offset:0
    ds_read_b128 v[108:111], v87 offset:4096
    v_and_b32 v28, 15, v1
    v_lshrrev_b32 v29, 4, v1
    v_mov_b32 v30, 1025
    v_lshlrev_b32 v31, 1, v28
    v_add_u32 v31, 240, v31
    s_mov_b32 s26, 0xfff0fff
    s_mov_b32 s27, s26
    v_cndmask_b32 v31, v30, v31, s[26:27]
    s_mov_b32 s26, 0xff00ff
    s_mov_b32 s27, s26
    v_cndmask_b32 v12, v31, v28, s[26:27]
    v_lshlrev_b32 v31, 8, v28
    s_mov_b32 s26, 0x1ff01ff
    s_mov_b32 s27, s26
    v_cndmask_b32 v31, v30, v31, s[26:27]
    v_lshrrev_b32 v32, 1, v28
    v_lshlrev_b32 v32, 8, v32
    v_and_b32 v33, 1, v28
    v_lshl_add_u32 v32, v33, 2, v32
    v_add_u32 v32, 512, v32
    s_waitcnt lgkmcnt(9)
    v_mfma_f32_16x16x32_f16 v[112:115], v[52:55], v[56:59], 0
    v_mfma_f32_16x16x32_f16 v[116:119], v[52:55], v[60:63], 0
    ds_read_b128 v[52:55], v80 offset:40960
    ds_read_b128 v[56:59], v84 offset:40960
    ds_read_b128 v[60:63], v84 offset:45056
    s_mov_b32 s26, 0xf000f
    s_mov_b32 s27, s26
    v_cndmask_b32 v13, v31, v32, s[26:27]
    s_mul_i32 s27, s20, 288
    s_add_u32 s27, s27, s58
    v_mul_u32_u24 v29, 72, v29
    v_add_u32 v29, s27, v29
    v_lshrrev_b32 v30, 4, v12
    v_lshl_add_u32 v12, v12, 1, v29
    v_lshl_add_u32 v12, v30, 2, v12
    v_lshrrev_b32 v30, 4, v13
    v_lshl_add_u32 v13, v13, 1, v29
    v_lshl_add_u32 v13, v30, 2, v13
    s_waitcnt lgkmcnt(9)
    v_mfma_f32_16x16x32_f16 v[112:115], v[64:67], v[68:71], v[112:115]
    v_mfma_f32_16x16x32_f16 v[116:119], v[64:67], v[72:75], v[116:119]
    ds_read_b128 v[64:67], v81 offset:40960
    ds_read_b128 v[68:71], v85 offset:40960
    ds_read_b128 v[72:75], v85 offset:45056
    s_lshl_b32 s27, s20, 10
    v_lshl_add_u32 v32, v1, 4, s27
    v_lshlrev_b32 v11, 1, v32
    v_sub_u32 v32, 2047, v32
    v_cvt_f32_u32 v28, v32
    v_add_f32 v29, -1.0, v28
    v_mov_b32 v30, -2.0
    v_mov_b32 v32, 513.0
    v_mov_b32 v33, s58
    v_cvt_pk_bf16_f32 v31, v28, v29
    v_pk_add_f32 v[28:29], v[28:29], v[30:31] op_sel_hi:[1,0]
    v_and_b32 v15, s59, v31
    v_lshlrev_b32 v14, 16, v31
    s_waitcnt lgkmcnt(9)
    v_mfma_f32_16x16x32_f16 v[112:115], v[88:91], v[92:95], v[112:115]
    v_mfma_f32_16x16x32_f16 v[116:119], v[88:91], v[96:99], v[116:119]
    ds_read_b128 v[88:91], v82 offset:40960
    ds_read_b128 v[92:95], v86 offset:40960
    ds_read_b128 v[96:99], v86 offset:45056
    v_cvt_u32_f32 v14, v14
    v_cvt_u32_f32 v15, v15
    v_lshrrev_b32 v34, 4, v14
    v_lshrrev_b32 v35, 4, v15
    v_lshl_add_u32 v14, v14, 1, v33
    v_lshl_add_u32 v15, v15, 1, v33
    v_lshl_add_u32 v14, v34, 2, v14
    v_lshl_add_u32 v15, v35, 2, v15
    s_waitcnt lgkmcnt(9)
    v_mfma_f32_16x16x32_f16 v[112:115], v[100:103], v[104:107], v[112:115]
    v_mfma_f32_16x16x32_f16 v[116:119], v[100:103], v[108:111], v[116:119]
    ds_read_b128 v[100:103], v83 offset:40960
    ds_read_b128 v[104:107], v87 offset:40960
    ds_read_b128 v[108:111], v87 offset:45056
    v_cvt_pk_bf16_f32 v31, v28, v29
    v_pk_add_f32 v[28:29], v[28:29], v[30:31] op_sel_hi:[1,0]
    v_and_b32 v27, s59, v31
    v_lshlrev_b32 v26, 16, v31
    v_cvt_u32_f32 v26, v26
    v_cvt_u32_f32 v27, v27
    v_lshrrev_b32 v34, 4, v26
    v_lshrrev_b32 v35, 4, v27
    s_waitcnt lgkmcnt(9)
    v_mfma_f32_16x16x32_f16 v[112:115], v[52:55], v[56:59], v[112:115]
    v_mfma_f32_16x16x32_f16 v[116:119], v[52:55], v[60:63], v[116:119]
    v_lshl_add_u32 v26, v26, 1, v33
    v_lshl_add_u32 v27, v27, 1, v33
    v_lshl_add_u32 v26, v34, 2, v26
    v_lshl_add_u32 v27, v35, 2, v27
    v_cvt_pk_bf16_f32 v31, v28, v29
    v_pk_add_f32 v[28:29], v[28:29], v[30:31] op_sel_hi:[1,0]
    v_and_b32 v41, s59, v31
    v_lshlrev_b32 v40, 16, v31
    s_waitcnt lgkmcnt(6)
    v_mfma_f32_16x16x32_f16 v[112:115], v[64:67], v[68:71], v[112:115]
    v_mfma_f32_16x16x32_f16 v[116:119], v[64:67], v[72:75], v[116:119]
    v_cvt_u32_f32 v40, v40
    v_cvt_u32_f32 v41, v41
    v_lshrrev_b32 v34, 4, v40
    v_lshrrev_b32 v35, 4, v41
    v_lshl_add_u32 v40, v40, 1, v33
    v_lshl_add_u32 v41, v41, 1, v33
    v_lshl_add_u32 v40, v34, 2, v40
    v_lshl_add_u32 v41, v35, 2, v41
    s_waitcnt lgkmcnt(3)
    v_mfma_f32_16x16x32_f16 v[112:115], v[88:91], v[92:95], v[112:115]
    v_mfma_f32_16x16x32_f16 v[116:119], v[88:91], v[96:99], v[116:119]
    v_cvt_pk_bf16_f32 v31, v28, v29
    v_pk_add_f32 v[28:29], v[28:29], v[30:31] op_sel_hi:[1,0]
    v_and_b32 v43, s59, v31
    v_lshlrev_b32 v42, 16, v31
    v_cvt_u32_f32 v42, v42
    v_cvt_u32_f32 v43, v43
    v_lshrrev_b32 v34, 4, v42
    v_lshrrev_b32 v35, 4, v43
    s_waitcnt lgkmcnt(0)
    v_mfma_f32_16x16x32_f16 v[112:115], v[100:103], v[104:107], v[112:115]
    v_mfma_f32_16x16x32_f16 v[116:119], v[100:103], v[108:111], v[116:119]
    v_lshl_add_u32 v42, v42, 1, v33
    v_lshl_add_u32 v43, v43, 1, v33
    v_lshl_add_u32 v42, v34, 2, v42
    v_lshl_add_u32 v43, v35, 2, v43
    v_cvt_pk_bf16_f32 v31, v28, v29
    v_pk_add_f32 v[28:29], v[28:29], v[30:31] op_sel_hi:[1,0]
    v_and_b32 v51, s59, v31
    v_lshlrev_b32 v50, 16, v31
    v_mov_b32 v120, s58
    v_mov_b32 v121, 0
    ds_write_b16 v120, v121 offset:1154
    v_cvt_u32_f32 v50, v50
    v_cvt_u32_f32 v51, v51
    v_lshrrev_b32 v34, 4, v50
    v_lshrrev_b32 v35, 4, v51
    v_lshl_add_u32 v50, v50, 1, v33
    v_lshl_add_u32 v51, v51, 1, v33
    v_lshl_add_u32 v50, v34, 2, v50
    v_lshl_add_u32 v51, v35, 2, v51
    v_pk_mul_f32 v[112:113], v[112:113], v[48:49] op_sel_hi:[1,0]
    v_pk_mul_f32 v[114:115], v[114:115], v[48:49] op_sel_hi:[1,0]
    v_pk_mul_f32 v[116:117], v[116:117], v[48:49] op_sel_hi:[1,0]
    v_pk_mul_f32 v[118:119], v[118:119], v[48:49] op_sel_hi:[1,0]
    v_cvt_pk_bf16_f32 v112, v112, v113
    v_cvt_pk_bf16_f32 v114, v114, v115
    v_cvt_pk_bf16_f32 v116, v116, v117
    v_cvt_pk_bf16_f32 v118, v118, v119
    ds_write_b16 v12, v112 offset:0
    ds_write_b16_d16_hi v12, v112 offset:16
    ds_write_b16 v12, v114 offset:36
    ds_write_b16_d16_hi v12, v114 offset:52
    ds_write_b16 v13, v116 offset:0
    ds_write_b16_d16_hi v13, v116 offset:16
    ds_write_b16 v13, v118 offset:36
    ds_write_b16_d16_hi v13, v118 offset:52
    v_cvt_pk_bf16_f32 v31, v28, v29
    v_pk_add_f32 v[28:29], v[28:29], v[30:31] op_sel_hi:[1,0]
    v_and_b32 v77, s59, v31
    v_lshlrev_b32 v76, 16, v31
    v_cvt_u32_f32 v76, v76
    v_cvt_u32_f32 v77, v77
    v_lshrrev_b32 v34, 4, v76
    v_lshrrev_b32 v35, 4, v77
    v_lshl_add_u32 v76, v76, 1, v33
    v_lshl_add_u32 v77, v77, 1, v33
    v_lshl_add_u32 v76, v34, 2, v76
    v_lshl_add_u32 v77, v35, 2, v77
    v_cvt_pk_bf16_f32 v31, v28, v29
    v_pk_add_f32 v[28:29], v[28:29], v[30:31] op_sel_hi:[1,0]
    v_and_b32 v79, s59, v31
    v_lshlrev_b32 v78, 16, v31
    v_cvt_u32_f32 v78, v78
    v_cvt_u32_f32 v79, v79
    v_lshrrev_b32 v34, 4, v78
    v_lshrrev_b32 v35, 4, v79
    v_lshl_add_u32 v78, v78, 1, v33
    v_lshl_add_u32 v79, v79, 1, v33
    v_lshl_add_u32 v78, v34, 2, v78
    v_lshl_add_u32 v79, v35, 2, v79
    v_cvt_pk_bf16_f32 v31, v28, v29
    v_pk_add_f32 v[28:29], v[28:29], v[30:31] op_sel_hi:[1,0]
    v_and_b32 v129, s59, v31
    v_lshlrev_b32 v128, 16, v31
    v_cvt_u32_f32 v128, v128
    v_cvt_u32_f32 v129, v129
    v_lshrrev_b32 v34, 4, v128
    v_lshrrev_b32 v35, 4, v129
    v_lshl_add_u32 v128, v128, 1, v33
    v_lshl_add_u32 v129, v129, 1, v33
    v_lshl_add_u32 v128, v34, 2, v128
    v_lshl_add_u32 v129, v35, 2, v129
    v_cvt_pk_bf16_f32 v31, v28, v29
    v_pk_add_f32 v[28:29], v[28:29], v[30:31] op_sel_hi:[1,0]
    v_and_b32 v131, s59, v31
    v_lshlrev_b32 v130, 16, v31
    v_cmp_gt_f32 s[28:29], 0, v130
    v_cmp_gt_f32 s[26:27], 0, v131
    s_nop 0
    v_cndmask_b32 v130, v130, v32, s[28:29]
    v_cndmask_b32 v131, v131, v32, s[26:27]
    v_cvt_u32_f32 v130, v130
    v_cvt_u32_f32 v131, v131
    v_lshrrev_b32 v34, 4, v130
    v_lshrrev_b32 v35, 4, v131
    v_lshl_add_u32 v130, v130, 1, v33
    v_lshl_add_u32 v131, v131, 1, v33
    v_lshl_add_u32 v130, v34, 2, v130
    v_lshl_add_u32 v131, v35, 2, v131
    v_cvt_pk_bf16_f32 v31, v28, v29
    v_and_b32 v133, s59, v31
    v_lshlrev_b32 v132, 16, v31
    v_cmp_gt_f32 s[28:29], 0, v132
    v_cmp_gt_f32 s[26:27], 0, v133
    s_nop 0
    v_cndmask_b32 v132, v132, v32, s[28:29]
    v_cndmask_b32 v133, v133, v32, s[26:27]
    v_cvt_u32_f32 v132, v132
    v_lshrrev_b32 v34, 4, v132
    v_lshl_add_u32 v132, v132, 1, v33
    v_lshl_add_u32 v132, v34, 2, v132
    s_lshl_b32 s27, s20, 6
    s_add_u32 s27, s27, s13
    s_add_u32 s27, s27, 30720
    v_lshl_add_u32 v36, v1, 2, s27
    s_mul_i32 s27, s19, 81920
    s_add_u32 s27, s27, 26624
    v_add_u32 v11, s27, v11
    s_waitcnt lgkmcnt(0)
    s_barrier
    ds_read_u16 v14, v14
    ds_read_u16 v15, v15
    ds_read_u16 v26, v26
    ds_read_u16 v27, v27
    ds_read_u16 v40, v40
    ds_read_u16 v41, v41
    ds_read_u16 v42, v42
    ds_read_u16 v43, v43
    ds_read_u16 v50, v50
    ds_read_u16 v51, v51
    ds_read_u16 v76, v76
    ds_read_u16 v77, v77
    ds_read_u16 v78, v78
    ds_read_u16 v79, v79
    ds_read_u16 v128, v128
    ds_read_u16 v129, v129
    ds_read_u16 v130, v130
    ds_read_u16 v131, v131
    ds_read_u16 v132, v132
    ds_write_b32 v36, v121
    ds_write_b32 v36, v121 offset:4384
    s_waitcnt lgkmcnt(2)
    v_lshl_or_b32 v112, v15, 16, v14
    v_lshl_or_b32 v113, v27, 16, v26
    v_lshl_or_b32 v114, v41, 16, v40
    v_lshl_or_b32 v115, v43, 16, v42
    v_lshl_or_b32 v116, v51, 16, v50
    v_lshl_or_b32 v117, v77, 16, v76
    v_lshl_or_b32 v118, v79, 16, v78
    v_lshl_or_b32 v119, v129, 16, v128
    ds_write_b128 v11, v[112:115] offset:0
    ds_write_b128 v11, v[116:119] offset:16
    v_lshl_or_b32 v120, v26, 16, v15
    v_lshl_or_b32 v121, v40, 16, v27
    v_lshl_or_b32 v122, v42, 16, v41
    v_lshl_or_b32 v123, v50, 16, v43
    v_lshl_or_b32 v124, v76, 16, v51
    v_lshl_or_b32 v125, v78, 16, v77
    v_lshl_or_b32 v126, v128, 16, v79
    v_lshl_or_b32 v127, v130, 16, v129
    ds_write_b128 v11, v[120:123] offset:4384
    ds_write_b128 v11, v[124:127] offset:4400
    v_lshl_or_b32 v112, v27, 16, v26
    v_lshl_or_b32 v113, v41, 16, v40
    v_lshl_or_b32 v114, v43, 16, v42
    v_lshl_or_b32 v115, v51, 16, v50
    v_lshl_or_b32 v116, v77, 16, v76
    v_lshl_or_b32 v117, v79, 16, v78
    v_lshl_or_b32 v118, v129, 16, v128
    v_lshl_or_b32 v119, v131, 16, v130
    ds_write_b128 v11, v[112:115] offset:41024
    ds_write_b128 v11, v[116:119] offset:41040
    v_lshl_or_b32 v120, v40, 16, v27
    v_lshl_or_b32 v121, v42, 16, v41
    v_lshl_or_b32 v122, v50, 16, v43
    v_lshl_or_b32 v123, v76, 16, v51
    v_lshl_or_b32 v124, v78, 16, v77
    v_lshl_or_b32 v125, v128, 16, v79
    v_lshl_or_b32 v126, v130, 16, v129
    v_lshl_or_b32 v127, v132, 16, v131
    ds_write_b128 v11, v[120:123] offset:45408
    ds_write_b128 v11, v[124:127] offset:45424
    s_mov_b32 s28, 0
L_poll9:
    global_load_dwordx2 v[24:25], v10, s[80:81] sc1
    s_add_u32 s28, s28, 1
    s_cmp_ge_u32 s28, 0x8000
    s_cbranch_scc1 L_poll9_ok
    s_waitcnt vmcnt(0)
    v_subrev_u32 v24, s100, v24
    v_cmp_ne_u32 s[26:27], s101, v25
    v_subrev_u32 v24, 1, v24
    v_cmp_lt_u32 vcc, 2, v24
    s_nop 1
    s_or_b64 s[26:27], s[26:27], vcc
    s_cbranch_scc1 L_poll9
L_poll9_ok:
    s_lshr_b32 s26, s14, 5
    s_lshl_b32 s26, s26, 18
    s_and_b32 s27, s14, 31
    s_lshl_b32 s27, s27, 5
    s_add_u32 s26, s26, s27
    s_lshl_b32 s27, s12, 16
    s_add_u32 s26, s26, s27
    s_add_u32 s26, s26, 2097152
    v_lshlrev_b32 v8, 10, v1
    s_lshl_b32 s27, s12, 10
    s_add_u32 m0, s27, 76928
    s_nop 0
    buffer_load_dwordx4 v8, s[8:11], s26 offen lds
    s_add_u32 s26, s26, 16
    s_add_u32 m0, s27, 158848
    s_nop 0
    buffer_load_dwordx4 v8, s[8:11], s26 offen lds
    s_mul_i32 s27, s19, 81920
    s_add_u32 s27, s27, 76416
    v_lshl_add_u32 v9, v1, 3, s27
    v_mov_b32 v10, 0
    v_mov_b32 v11, 0
    ds_write_b64 v9, v[10:11]
    v_and_b32 v100, 15, v1
    v_lshrrev_b32 v101, 5, v1
    v_bfe_u32 v102, v1, 4, 1
    v_sub_u32 v26, v100, v101
    v_lshlrev_b32 v26, 5, v26
    v_lshl_add_u32 v26, v102, 4, v26
    v_lshlrev_b32 v27, 4, v102
    v_lshlrev_b32 v103, 5, v101
    v_sub_u32 v27, v27, v103
    v_lshlrev_b32 v103, 1, v100
    v_sub_u32 v27, v27, v103
    v_sub_u32 v103, 3, v100
    v_and_b32 v101, 1, v103
    v_mul_u32_u24 v101, 4382, v101
    v_add_u32 v27, v27, v101
    v_bfe_u32 v101, v103, 1, 1
    v_mul_u32_u24 v101, 41020, v101
    v_add_u32 v27, v27, v101
    s_mul_i32 s27, s19, 81920
    s_lshl_b32 s28, s20, 7
    s_sub_u32 s27, s27, s28
    s_add_u32 s26, s27, 76608
    v_add_u32 v26, s26, v26
    s_add_u32 s26, s27, 26814
    v_add_u32 v27, s26, v27
    v_add_u32 v36, 2048, v27
    s_add_u32 s26, s13, 18432
    v_lshl_add_u32 v112, v1, 4, s26
    s_xor_b32 s27, s12, 1
    s_mul_i32 s27, s27, 40960
    s_add_u32 s27, s27, 18432
    v_lshl_add_u32 v113, v1, 4, s27
    v_lshrrev_b32 v101, 4, v1
    v_lshlrev_b32 v102, 5, v100
    v_lshl_add_u32 v102, v101, 3, v102
    s_mul_i32 s27, s19, 81920
    s_lshl_b32 s28, s20, 11
    s_add_u32 s27, s27, s28
    s_add_u32 s27, s27, 76928
    v_add_u32 v114, s27, v102
    s_lshl_b32 s27, s21, 12
    s_add_u32 s27, s27, s28
    s_add_u32 s27, s27, 8388608
    v_add_u32 v115, s27, v102
    v_lshlrev_b32 v101, 8, v101
    v_lshl_add_u32 v101, v100, 3, v101
    s_add_u32 s27, s13, 26624
    v_add_u32 v120, s27, v101
    v_lshrrev_b32 v100, 1, v1
    v_lshlrev_b32 v100, 12, v100
    v_and_b32 v101, 1, v1
    v_lshl_add_u32 v121, v101, 4, v100
    s_lshl_b32 s30, s31, 1
    s_lshl_b32 s27, s18, 18
    s_add_u32 s30, s30, s27
    s_add_u32 s30, s30, 8388608
    v_min_u32 v100, 6, v1
    s_lshl_b32 s26, s18, 5
    s_mul_i32 s27, s12, 7
    s_add_u32 s27, s27, s26
    s_lshl_b32 s27, s27, 3
    s_add_u32 s27, s27, 12648448
    v_lshl_add_u32 v122, v100, 3, s27
    v_and_b32 v100, 31, v1
    s_lshl_b32 s26, s18, 8
    s_add_u32 s26, s26, 12582912
    v_lshl_add_u32 v123, v100, 3, s26
    v_and_b32 v136, 31, v1
    v_lshrrev_b32 v137, 5, v1
    v_xor_b32 v137, v137, v136
    v_and_b32 v137, 7, v137
    v_lshlrev_b32 v136, 7, v136
    v_lshl_add_u32 v136, v137, 4, v136
    s_add_u32 s26, s13, 18432
    v_add_u32 v100, s26, v136
    v_xor_b32 v101, 32, v100
    v_xor_b32 v102, 64, v100
    v_xor_b32 v103, 96, v100
    v_lshrrev_b32 v136, 4, v1
    v_lshlrev_b32 v136, 1, v136
    v_and_b32 v137, 7, v1
    v_xor_b32 v136, v136, v137
    v_and_b32 v137, 15, v1
    v_lshlrev_b32 v137, 7, v137
    v_lshl_add_u32 v136, v136, 4, v137
    s_lshl_b32 s26, s12, 11
    s_add_u32 s26, s26, 18432
    v_add_u32 v132, s26, v136
    v_xor_b32 v133, 16, v132
    v_add_u32 v134, 81920, v132
    v_add_u32 v135, 81920, v133
    v_lshlrev_b32 v44, 16, v44
    v_lshlrev_b32 v38, 16, v38
    v_mov_b32 v45, v44
    v_mov_b32 v39, v38
    global_load_dwordx4 v[136:139], v3, s[48:49]
    global_load_dwordx4 v[140:143], v3, s[48:49] offset:64
    s_add_u32 m0, s13, 0
    s_nop 0
    buffer_load_dwordx4 v20, s[84:87], s88 offen offset:0 lds
    buffer_load_dwordx4 v21, s[84:87], s88 offen offset:1024 lds
    buffer_load_dwordx4 v22, s[84:87], s88 offen offset:2048 lds
    buffer_load_dwordx4 v23, s[84:87], s88 offen offset:3072 lds
    s_add_u32 s88, s88, 131072
    s_add_u32 m0, s13, 4096
    s_nop 0
    buffer_load_dwordx4 v20, s[84:87], s88 offen offset:0 lds
    s_waitcnt vmcnt(0) lgkmcnt(0)
    s_barrier
    ds_read2_b64 v[12:15], v36 offset0:232 offset1:233
    ds_read_b128 v[56:59], v26 offset:320
    ds_read_b128 v[60:63], v26 offset:832
    ds_read_b128 v[64:67], v26 offset:1344
    ds_read_b128 v[68:71], v26 offset:1856
    ds_read_b128 v[80:83], v26 offset:2368
    ds_read_b128 v[84:87], v26 offset:2880
    ds_read_b128 v[88:91], v26 offset:3392
    ds_read_b128 v[92:95], v26 offset:3904
    ds_read2_b64 v[40:43], v36 offset0:200 offset1:201
    ds_read_b128 v[96:99], v26 offset:64
    ds_read_b128 v[104:107], v26 offset:576
    s_waitcnt vmcnt(0) lgkmcnt(0)
    s_branch L_join
.section .rodata,"a"
.p2align 6
.amdhsa_kernel recurrent_scan__ssm_conv_s4__mixer_token_mlp__prompt_kernel
  .amdhsa_next_free_vgpr 512
  .amdhsa_next_free_sgpr 102
  .amdhsa_accum_offset 256
  .amdhsa_group_segment_fixed_size 0
  .amdhsa_kernarg_size 136
  .amdhsa_user_sgpr_count 2
  .amdhsa_user_sgpr_kernarg_segment_ptr 1
  .amdhsa_system_sgpr_workgroup_id_x 1
  .amdhsa_float_denorm_mode_32 3
.end_amdhsa_kernel
```
